```python
import torch

def _softmax(x, axis=-1):
    return torch.softmax(x, dim=axis)
def _gelu(x):
    return torch.nn.functional.gelu(x, approximate="tanh")
def _silu(x):
    return torch.nn.functional.silu(x)
def _sigmoid(x):
    return torch.sigmoid(x)
def _layernorm(x, axis=-1, eps=1e-5):
    m = x.mean(dim=axis, keepdim=True)
    v = x.var(dim=axis, keepdim=True, unbiased=False)
    return (x - m) / torch.sqrt(v + eps)
def _scatter_add(tgt, idx, src, axis=0):
    return tgt.clone().index_add_(axis, idx, src)
def _segment_sum(src, seg, n):
    out = torch.zeros((n,) + src.shape[1:], dtype=src.dtype)
    return out.index_add_(0, seg, src)
def _pad(x, pw):
    flat = tuple(v for pair in reversed(pw) for v in pair)
    return torch.nn.functional.pad(x, flat)

kernel_name = 'gated_mix__ssm_conv_s5__dense_activation_mish__prompt'

def setup_inputs():

    _w = (lambda a: (lambda t: t.to(torch.bfloat16) if t.is_floating_point() else t)(torch.as_tensor(a)))
    def _A_setup():
        B, S, D = 1, 2048, 640
        P = D
        Lambda_re = -0.5 * (lambda _x: torch.exp(torch.as_tensor(_x)))((lambda *s: torch.randn(*s, dtype=torch.bfloat16) * 0.2)(P))
        Lambda_im = (lambda *s: torch.randn(*s, dtype=torch.bfloat16) * 0.2)(P) * 1.0
        B_re = (lambda *s: torch.randn(*s, dtype=torch.bfloat16) * 0.2)(P, D) * (D ** -0.5)
        B_im = (lambda *s: torch.randn(*s, dtype=torch.bfloat16) * 0.2)(P, D) * (D ** -0.5)
        C_re = (lambda *s: torch.randn(*s, dtype=torch.bfloat16) * 0.2)(D, P) * (P ** -0.5)
        C_im = (lambda *s: torch.randn(*s, dtype=torch.bfloat16) * 0.2)(D, P) * (P ** -0.5)
        log_dt = (lambda *s: torch.randn(*s, dtype=torch.bfloat16) * 0.2)(P) * 0.3 - 2.0
        Dskip = (lambda *s: torch.randn(*s, dtype=torch.bfloat16) * 0.05)(D)
        return {
            "x": _w((lambda *s: torch.randn(*s, dtype=torch.bfloat16) * 0.05)(B, S, D)),
            "Lambda_re": _w(Lambda_re),
            "Lambda_im": _w(Lambda_im),
            "B_re": _w(B_re),
            "B_im": _w(B_im),
            "C_re": _w(C_re),
            "C_im": _w(C_im),
            "log_dt": _w(log_dt),
            "Dskip": _w(Dskip),
        }
    _A_in = _A_setup()

    def _B_setup():
        B, S, D, F = 1, 2048, 640, 1536
        return {
            "x": _w((lambda *s: torch.randn(*s, dtype=torch.bfloat16) * 0.05)(B, S, D)),
            "w1": _w((lambda *s: torch.randn(*s, dtype=torch.bfloat16) * 3.2)(D, F) * (D ** -0.5)),
            "b1": _w((lambda *s: torch.randn(*s, dtype=torch.bfloat16) * 0.05)(F)),
            "w2": _w((lambda *s: torch.randn(*s, dtype=torch.bfloat16) * 0.05)(F, D) * (F ** -0.5)),
        }
    _B_in = _B_setup()

    return {
        "A_x": _A_in["x"],
        "A_Lambda_re": _A_in["Lambda_re"],
        "A_Lambda_im": _A_in["Lambda_im"],
        "A_B_re": _A_in["B_re"],
        "A_B_im": _A_in["B_im"],
        "A_C_re": _A_in["C_re"],
        "A_C_im": _A_in["C_im"],
        "A_log_dt": _A_in["log_dt"],
        "A_Dskip": _A_in["Dskip"],
        "B_x": _B_in["x"],
        "B_w1": _B_in["w1"],
        "B_b1": _B_in["b1"],
        "B_w2": _B_in["w2"],
        "gate_w": _w((lambda *s: torch.randn(*s, dtype=torch.bfloat16) * 0.05)(640) * 16.0),
    }

def reference(A_x, A_Lambda_re, A_Lambda_im, A_B_re, A_B_im, A_C_re, A_C_im, A_log_dt, A_Dskip, B_x, B_w1, B_b1, B_w2, gate_w):
    def _A_ref(x, Lambda_re, Lambda_im, B_re, B_im, C_re, C_im, log_dt, Dskip):
        Bsz, L, H = x.shape
        Lam = Lambda_re + 1j * Lambda_im
        Bmat = B_re + 1j * B_im
        Cmat = C_re + 1j * C_im
        dt = torch.exp(log_dt)
        Lam_bar = torch.exp(dt * Lam)
        B_bar = ((Lam_bar - 1.0) / Lam)[:, None] * Bmat
        Bu = torch.einsum("bld,pd->blp", x + 0j, B_bar)
        h = torch.zeros_like(Bu[:, 0, :])
        hs = []
        for t in range(L):
            h = Lam_bar[None, :] * h + Bu[:, t, :]
            hs.append(h)
        hseq = torch.stack(hs, 1)
        y = 2.0 * torch.einsum("blp,dp->bld", hseq, Cmat).real + x * Dskip[None, None, :]
        return y

    def _B_ref(x, w1, b1, w2):
        h = torch.einsum("bsd,df->bsf", x, w1) + b1
        sp = torch.log1p(torch.exp(-torch.abs(h))) + torch.where(h > 0, h, torch.zeros_like(h))
        act = h * torch.tanh(sp)
        return torch.einsum("bsf,fd->bsd", act, w2)

    x = A_x
    g = _sigmoid((x * gate_w).sum(-1, keepdims=True))
    a = _A_ref(x, A_Lambda_re, A_Lambda_im, A_B_re, A_B_im, A_C_re, A_C_im, A_log_dt, A_Dskip)
    b = _B_ref(x, B_w1, B_b1, B_w2)
    return g * a + (1 - g) * b
```

```asm
; @launch grid=(256,1,1) block=(512,1,1) lds=163840
.amdgcn_target "amdgcn-amd-amdhsa--gfx950"
.text
.globl gated_mix__ssm_conv_s5__dense_activation_mish__prompt_kernel
.p2align 8
.type gated_mix__ssm_conv_s5__dense_activation_mish__prompt_kernel,@function
gated_mix__ssm_conv_s5__dense_activation_mish__prompt_kernel:
    s_cmp_ge_u32 s2, 256
    s_cbranch_scc1 k_end
    s_load_dwordx8 s[16:23], s[0:1], 0
    s_load_dwordx2 s[24:25], s[0:1], 32
    s_load_dwordx4 s[4:7], s[0:1], 40
    s_load_dwordx2 s[26:27], s[0:1], 56
    s_load_dwordx2 s[8:9], s[0:1], 64
    s_load_dwordx8 s[28:35], s[0:1], 80
    s_load_dwordx2 s[10:11], s[0:1], 112
    s_load_dwordx4 s[36:39], s[0:1], 120
    v_lshrrev_b32 v2, 6, v0
    v_and_b32 v1, 63, v0
    s_nop 0
    v_readfirstlane_b32 s75, v2
    s_and_b32 s76, s2, 7
    s_lshr_b32 s77, s2, 3
    s_and_b32 s78, s76, 1
    s_lshr_b32 s79, s76, 1
    s_mul_i32 s64, s78, 8
    s_and_b32 s78, s77, 7
    s_add_u32 s64, s64, s78
    s_mul_i32 s65, s79, 4
    s_lshr_b32 s78, s77, 3
    s_add_u32 s65, s65, s78
    s_and_b32 s78, s76, 7
    s_lshr_b32 s79, s76, 3
    s_mul_i32 s12, s78, 4
    s_and_b32 s78, s77, 3
    s_add_u32 s12, s12, s78
    s_mul_i32 s13, s79, 8
    s_lshr_b32 s78, s77, 2
    s_add_u32 s13, s13, s78
    s_and_b32 s66, s75, 3
    s_cmp_ge_u32 s75, 4
    s_cbranch_scc0 k_compute
    s_setprio 3
    s_lshl_b32 s76, s64, 7
    s_lshl_b32 s77, s66, 5
    s_add_u32 s76, s76, s77
    v_lshrrev_b32 v24, 3, v1
    v_add_u32 v24, s76, v24
    v_mul_u32_u24 v24, 1280, v24
    v_bfe_u32 v25, v1, 4, 1
    v_and_b32 v26, 7, v1
    v_xor_b32 v25, v25, v26
    v_xor_b32 v26, 0, v25
    v_lshlrev_b32 v26, 4, v26
    v_add_u32 v26, v24, v26
    v_add_u32 v2, 0, v26
    v_xor_b32 v26, 2, v25
    v_lshlrev_b32 v26, 4, v26
    v_add_u32 v26, v24, v26
    v_add_u32 v3, 10240, v26
    v_xor_b32 v26, 4, v25
    v_lshlrev_b32 v26, 4, v26
    v_add_u32 v26, v24, v26
    v_add_u32 v4, 20480, v26
    v_xor_b32 v26, 6, v25
    v_lshlrev_b32 v26, 4, v26
    v_add_u32 v26, v24, v26
    v_add_u32 v5, 30720, v26
    s_mul_i32 s76, s66, 20
    s_lshr_b32 s77, s66, 1
    s_mul_i32 s78, s77, 40
    s_mul_i32 s79, s65, 40
    s_sub_u32 s79, s79, s78
    v_lshrrev_b32 v24, 3, v1
    v_add_u32 v24, s76, v24
    v_and_b32 v25, 6, v24
    v_or_b32 v25, s77, v25
    v_and_b32 v26, 7, v1
    v_xor_b32 v25, v25, v26
    v_lshlrev_b32 v25, 4, v25
    v_add_u32 v24, s79, v24
    v_mul_u32_u24 v24, 1280, v24
    v_add_u32 v6, v24, v25
    v_lshrrev_b32 v24, 3, v1
    v_add_u32 v24, s76, v24
    v_add_u32 v24, 8, v24
    v_and_b32 v25, 6, v24
    v_or_b32 v25, s77, v25
    v_and_b32 v26, 7, v1
    v_xor_b32 v25, v25, v26
    v_lshlrev_b32 v25, 4, v25
    v_add_u32 v24, s79, v24
    v_mul_u32_u24 v24, 1280, v24
    v_add_u32 v7, v24, v25
    v_lshrrev_b32 v24, 3, v1
    v_add_u32 v24, s76, v24
    v_add_u32 v24, 16, v24
    v_and_b32 v25, 6, v24
    v_or_b32 v25, s77, v25
    v_and_b32 v26, 7, v1
    v_xor_b32 v25, v25, v26
    v_lshlrev_b32 v25, 4, v25
    v_add_u32 v24, s79, v24
    v_mul_u32_u24 v24, 1280, v24
    v_add_u32 v8, v24, v25
    s_lshl_b32 s76, s66, 4
    s_mul_i32 s77, s65, 192
    v_add_u32 v24, 0, v1
    v_mul_u32_u24 v25, 0x5556, v24
    v_lshrrev_b32 v25, 18, v25
    v_mul_u32_u24 v26, 12, v25
    v_sub_u32 v26, v24, v26
    v_lshrrev_b32 v27, 1, v26
    v_bfe_u32 v28, v25, 3, 1
    v_sub_u32 v27, v27, v28
    v_add_u32 v28, 6, v27
    v_cmp_gt_i32 vcc, 0, v27
    s_nop 1
    v_cndmask_b32 v27, v27, v28, vcc
    v_and_b32 v26, 1, v26
    v_lshl_add_u32 v27, v27, 1, v26
    v_lshlrev_b32 v27, 4, v27
    v_add_u32 v25, s76, v25
    v_mul_u32_u24 v25, 3072, v25
    v_add_u32 v25, s77, v25
    v_add_u32 v9, v25, v27
    v_add_u32 v24, 64, v1
    v_mul_u32_u24 v25, 0x5556, v24
    v_lshrrev_b32 v25, 18, v25
    v_mul_u32_u24 v26, 12, v25
    v_sub_u32 v26, v24, v26
    v_lshrrev_b32 v27, 1, v26
    v_bfe_u32 v28, v25, 3, 1
    v_sub_u32 v27, v27, v28
    v_add_u32 v28, 6, v27
    v_cmp_gt_i32 vcc, 0, v27
    s_nop 1
    v_cndmask_b32 v27, v27, v28, vcc
    v_and_b32 v26, 1, v26
    v_lshl_add_u32 v27, v27, 1, v26
    v_lshlrev_b32 v27, 4, v27
    v_add_u32 v25, s76, v25
    v_mul_u32_u24 v25, 3072, v25
    v_add_u32 v25, s77, v25
    v_add_u32 v10, v25, v27
    v_add_u32 v24, 128, v1
    v_mul_u32_u24 v25, 0x5556, v24
    v_lshrrev_b32 v25, 18, v25
    v_mul_u32_u24 v26, 12, v25
    v_sub_u32 v26, v24, v26
    v_lshrrev_b32 v27, 1, v26
    v_bfe_u32 v28, v25, 3, 1
    v_sub_u32 v27, v27, v28
    v_add_u32 v28, 6, v27
    v_cmp_gt_i32 vcc, 0, v27
    s_nop 1
    v_cndmask_b32 v27, v27, v28, vcc
    v_and_b32 v26, 1, v26
    v_lshl_add_u32 v27, v27, 1, v26
    v_lshlrev_b32 v27, 4, v27
    v_add_u32 v25, s76, v25
    v_mul_u32_u24 v25, 3072, v25
    v_add_u32 v25, s77, v25
    v_add_u32 v11, v25, v27
    s_lshl_b32 s67, s66, 12
    s_mul_i32 s68, s66, 2560
    s_add_u32 s68, s68, 16384
    s_mul_i32 s69, s66, 3072
    s_add_u32 s69, s69, 26624
    s_mul_i32 s76, s64, 1
    s_mul_i32 s77, s65, 3
    s_add_u32 s76, s76, s77
    s_mul_i32 s77, s76, 9363
    s_lshr_b32 s77, s77, 16
    s_mul_i32 s77, s77, 7
    s_sub_u32 s76, s76, s77
    s_lshl_b32 s70, s76, 7
    s_mul_i32 s71, s76, 196608
    s_mov_b32 s73, 0
    s_waitcnt lgkmcnt(0)
    s_mov_b32 s40, s16
    s_and_b32 s41, s17, 0xffff
    s_mov_b32 s42, 2621440
    s_mov_b32 s43, 0x00020000
    s_cmp_ge_u32 s66, 2
    s_cselect_b32 s76, s24, s22
    s_cselect_b32 s77, s25, s23
    s_mov_b32 s44, s76
    s_and_b32 s45, s77, 0xffff
    s_mov_b32 s46, 819200
    s_mov_b32 s47, 0x00020000
    s_mov_b32 s48, s28
    s_and_b32 s49, s29, 0xffff
    s_mov_b32 s50, 1966080
    s_mov_b32 s51, 0x00020000
    s_add_u32 s76, s67, s73
    s_add_u32 m0, s76, 0
    s_nop 0
    buffer_load_dwordx4 v2, s[40:43], s70 offen lds
    s_add_u32 s76, s67, s73
    s_add_u32 m0, s76, 1024
    s_nop 0
    buffer_load_dwordx4 v3, s[40:43], s70 offen lds
    s_add_u32 s76, s67, s73
    s_add_u32 m0, s76, 2048
    s_nop 0
    buffer_load_dwordx4 v4, s[40:43], s70 offen lds
    s_add_u32 s76, s67, s73
    s_add_u32 m0, s76, 3072
    s_nop 0
    buffer_load_dwordx4 v5, s[40:43], s70 offen lds
    s_add_u32 s76, s69, s73
    s_add_u32 m0, s76, 0
    s_nop 0
    buffer_load_dwordx4 v9, s[48:51], s71 offen lds
    s_add_u32 s76, s69, s73
    s_add_u32 m0, s76, 1024
    s_nop 0
    buffer_load_dwordx4 v10, s[48:51], s71 offen lds
    s_add_u32 s76, s69, s73
    s_add_u32 m0, s76, 2048
    s_nop 0
    buffer_load_dwordx4 v11, s[48:51], s71 offen lds
    s_add_u32 s76, s68, s73
    s_add_u32 m0, s76, 0
    s_nop 0
    buffer_load_dwordx4 v6, s[44:47], s70 offen lds
    s_add_u32 s76, s68, s73
    s_add_u32 m0, s76, 1024
    s_nop 0
    buffer_load_dwordx4 v7, s[44:47], s70 offen lds
    s_add_u32 s76, s68, s73
    s_add_u32 m0, s76, 2048
    s_mov_b64 exec, 0xffffffff
    buffer_load_dwordx4 v8, s[44:47], s70 offen lds
    s_mov_b64 exec, -1
    s_add_u32 s70, s70, 128
    s_add_u32 s71, s71, 196608
    s_cmp_ge_u32 s70, 1280
    s_cselect_b32 s70, 0, s70
    s_cselect_b32 s71, 0, s71
    s_add_u32 s73, s73, 38912
    s_cmp_ge_u32 s73, 116736
    s_cselect_b32 s73, 0, s73
    s_mov_b32 s52, s38
    s_and_b32 s53, s39, 0xffff
    s_mov_b32 s54, 268435456
    s_mov_b32 s55, 0x00020000
    s_mov_b32 s56, s36
    s_and_b32 s57, s37, 0xffff
    s_mov_b32 s58, 256
    s_mov_b32 s59, 0x00020000
    s_cmp_eq_u32 s66, 0
    s_cbranch_scc0 k1_p_notw0
    s_mul_i32 s76, s65, 40
    v_min_u32 v24, 39, v1
    v_add_u32 v24, s76, v24
    v_lshlrev_b32 v24, 1, v24
    global_load_ushort v30, v24, s[18:19]
    global_load_ushort v31, v24, s[20:21]
    global_load_ushort v32, v24, s[26:27]
k1_p_notw0:
    s_cmp_ge_u32 s66, 2
    s_cbranch_scc0 k1_p_notgate
    v_subrev_u32 v24, 384, v0
    v_lshrrev_b32 v25, 4, v24
    s_lshl_b32 s76, s64, 7
    s_lshl_b32 s77, s65, 3
    s_add_u32 s76, s76, s77
    v_add_u32 v25, s76, v25
    v_mul_u32_u24 v25, 1280, v25
    v_and_b32 v24, 15, v24
    v_lshlrev_b32 v24, 4, v24
    v_add_u32 v25, v25, v24
    global_load_dwordx4 v[64:67], v25, s[16:17] offset:0
    global_load_dwordx4 v[84:87], v24, s[34:35] offset:0
    global_load_dwordx4 v[68:71], v25, s[16:17] offset:256
    global_load_dwordx4 v[88:91], v24, s[34:35] offset:256
    global_load_dwordx4 v[72:75], v25, s[16:17] offset:512
    global_load_dwordx4 v[92:95], v24, s[34:35] offset:512
    global_load_dwordx4 v[76:79], v25, s[16:17] offset:768
    global_load_dwordx4 v[96:99], v24, s[34:35] offset:768
    global_load_dwordx4 v[80:83], v25, s[16:17] offset:1024
    global_load_dwordx4 v[100:103], v24, s[34:35] offset:1024
k1_p_notgate:
    s_add_u32 s76, s67, s73
    s_add_u32 m0, s76, 0
    s_nop 0
    buffer_load_dwordx4 v2, s[40:43], s70 offen lds
    s_add_u32 s76, s67, s73
    s_add_u32 m0, s76, 1024
    s_nop 0
    buffer_load_dwordx4 v3, s[40:43], s70 offen lds
    s_add_u32 s76, s67, s73
    s_add_u32 m0, s76, 2048
    s_nop 0
    buffer_load_dwordx4 v4, s[40:43], s70 offen lds
    s_add_u32 s76, s67, s73
    s_add_u32 m0, s76, 3072
    s_nop 0
    buffer_load_dwordx4 v5, s[40:43], s70 offen lds
    s_add_u32 s76, s69, s73
    s_add_u32 m0, s76, 0
    s_nop 0
    buffer_load_dwordx4 v9, s[48:51], s71 offen lds
    s_add_u32 s76, s69, s73
    s_add_u32 m0, s76, 1024
    s_nop 0
    buffer_load_dwordx4 v10, s[48:51], s71 offen lds
    s_add_u32 s76, s69, s73
    s_add_u32 m0, s76, 2048
    s_nop 0
    buffer_load_dwordx4 v11, s[48:51], s71 offen lds
    s_add_u32 s76, s68, s73
    s_add_u32 m0, s76, 0
    s_nop 0
    buffer_load_dwordx4 v6, s[44:47], s70 offen lds
    s_add_u32 s76, s68, s73
    s_add_u32 m0, s76, 1024
    s_nop 0
    buffer_load_dwordx4 v7, s[44:47], s70 offen lds
    s_add_u32 s76, s68, s73
    s_add_u32 m0, s76, 2048
    s_mov_b64 exec, 0xffffffff
    buffer_load_dwordx4 v8, s[44:47], s70 offen lds
    s_mov_b64 exec, -1
    s_add_u32 s70, s70, 128
    s_add_u32 s71, s71, 196608
    s_cmp_ge_u32 s70, 1280
    s_cselect_b32 s70, 0, s70
    s_cselect_b32 s71, 0, s71
    s_add_u32 s73, s73, 38912
    s_cmp_ge_u32 s73, 116736
    s_cselect_b32 s73, 0, s73
    s_waitcnt vmcnt(10)
    s_barrier
    s_add_u32 s76, s67, s73
    s_add_u32 m0, s76, 0
    s_nop 0
    buffer_load_dwordx4 v2, s[40:43], s70 offen lds
    s_add_u32 s76, s67, s73
    s_add_u32 m0, s76, 1024
    s_nop 0
    buffer_load_dwordx4 v3, s[40:43], s70 offen lds
    s_add_u32 s76, s67, s73
    s_add_u32 m0, s76, 2048
    s_nop 0
    buffer_load_dwordx4 v4, s[40:43], s70 offen lds
    s_add_u32 s76, s67, s73
    s_add_u32 m0, s76, 3072
    s_nop 0
    buffer_load_dwordx4 v5, s[40:43], s70 offen lds
    s_add_u32 s76, s69, s73
    s_add_u32 m0, s76, 0
    s_nop 0
    buffer_load_dwordx4 v9, s[48:51], s71 offen lds
    s_add_u32 s76, s69, s73
    s_add_u32 m0, s76, 1024
    s_nop 0
    buffer_load_dwordx4 v10, s[48:51], s71 offen lds
    s_add_u32 s76, s69, s73
    s_add_u32 m0, s76, 2048
    s_nop 0
    buffer_load_dwordx4 v11, s[48:51], s71 offen lds
    s_add_u32 s76, s68, s73
    s_add_u32 m0, s76, 0
    s_nop 0
    buffer_load_dwordx4 v6, s[44:47], s70 offen lds
    s_add_u32 s76, s68, s73
    s_add_u32 m0, s76, 1024
    s_nop 0
    buffer_load_dwordx4 v7, s[44:47], s70 offen lds
    s_add_u32 s76, s68, s73
    s_add_u32 m0, s76, 2048
    s_mov_b64 exec, 0xffffffff
    buffer_load_dwordx4 v8, s[44:47], s70 offen lds
    s_mov_b64 exec, -1
    s_add_u32 s70, s70, 128
    s_add_u32 s71, s71, 196608
    s_cmp_ge_u32 s70, 1280
    s_cselect_b32 s70, 0, s70
    s_cselect_b32 s71, 0, s71
    s_add_u32 s73, s73, 38912
    s_cmp_ge_u32 s73, 116736
    s_cselect_b32 s73, 0, s73
    s_lshl_b32 s76, s66, 5
    v_lshrrev_b32 v24, 3, v1
    v_add_u32 v24, s76, v24
    v_lshlrev_b32 v24, 7, v24
    s_mul_i32 s77, s12, 360448
    v_add_u32 v24, s77, v24
    v_bfe_u32 v25, v1, 1, 2
    v_bfe_u32 v26, v1, 4, 1
    v_xor_b32 v25, v25, v26
    v_and_b32 v26, 1, v1
    v_xor_b32 v27, 0, v25
    v_lshl_add_u32 v27, v27, 1, v26
    v_lshl_add_u32 v27, v27, 4, v24
    v_add_u32 v104, 0, v27
    v_xor_b32 v27, 2, v25
    v_lshl_add_u32 v27, v27, 1, v26
    v_lshl_add_u32 v27, v27, 4, v24
    v_add_u32 v105, 1024, v27
    v_xor_b32 v27, 0, v25
    v_lshl_add_u32 v27, v27, 1, v26
    v_lshl_add_u32 v27, v27, 4, v24
    v_add_u32 v106, 2048, v27
    v_xor_b32 v27, 2, v25
    v_lshl_add_u32 v27, v27, 1, v26
    v_lshl_add_u32 v27, v27, 4, v24
    v_add_u32 v107, 3072, v27
    s_mul_i32 s76, s66, 20
    s_mul_i32 s77, s13, 80
    v_lshrrev_b32 v24, 4, v1
    v_add_u32 v24, s76, v24
    v_xor_b32 v25, v24, v1
    v_and_b32 v25, 15, v25
    v_lshlrev_b32 v25, 4, v25
    v_add_u32 v24, s77, v24
    v_mul_u32_u24 v26, 1280, v24
    v_add_u32 v108, v26, v25
    v_mul_u32_u24 v26, 3072, v24
    v_add_u32 v26, v26, v25
    v_add_u32 v144, 0xc00000, v26
    v_lshrrev_b32 v24, 4, v1
    v_add_u32 v24, s76, v24
    v_add_u32 v24, 4, v24
    v_xor_b32 v25, v24, v1
    v_and_b32 v25, 15, v25
    v_lshlrev_b32 v25, 4, v25
    v_add_u32 v24, s77, v24
    v_mul_u32_u24 v26, 1280, v24
    v_add_u32 v109, v26, v25
    v_mul_u32_u24 v26, 3072, v24
    v_add_u32 v26, v26, v25
    v_add_u32 v145, 0xc00000, v26
    v_lshrrev_b32 v24, 4, v1
    v_add_u32 v24, s76, v24
    v_add_u32 v24, 8, v24
    v_xor_b32 v25, v24, v1
    v_and_b32 v25, 15, v25
    v_lshlrev_b32 v25, 4, v25
    v_add_u32 v24, s77, v24
    v_mul_u32_u24 v26, 1280, v24
    v_add_u32 v110, v26, v25
    v_mul_u32_u24 v26, 3072, v24
    v_add_u32 v26, v26, v25
    v_add_u32 v146, 0xc00000, v26
    v_lshrrev_b32 v24, 4, v1
    v_add_u32 v24, s76, v24
    v_add_u32 v24, 12, v24
    v_xor_b32 v25, v24, v1
    v_and_b32 v25, 15, v25
    v_lshlrev_b32 v25, 4, v25
    v_add_u32 v24, s77, v24
    v_mul_u32_u24 v26, 1280, v24
    v_add_u32 v111, v26, v25
    v_mul_u32_u24 v26, 3072, v24
    v_add_u32 v26, v26, v25
    v_add_u32 v147, 0xc00000, v26
    v_lshrrev_b32 v24, 4, v1
    v_add_u32 v24, s76, v24
    v_add_u32 v24, 16, v24
    v_xor_b32 v25, v24, v1
    v_and_b32 v25, 15, v25
    v_lshlrev_b32 v25, 4, v25
    v_add_u32 v24, s77, v24
    v_mul_u32_u24 v26, 1280, v24
    v_add_u32 v112, v26, v25
    v_mul_u32_u24 v26, 3072, v24
    v_add_u32 v26, v26, v25
    v_add_u32 v148, 0xc00000, v26
    s_lshl_b32 s60, s66, 12
    s_mul_i32 s61, s66, 5120
    s_add_u32 s61, s61, 16384
    s_mul_i32 s76, s12, 2
    s_mul_i32 s77, s13, 1
    s_add_u32 s76, s76, s77
    s_mul_i32 s77, s76, 21846
    s_lshr_b32 s77, s77, 16
    s_mul_i32 s77, s77, 3
    s_sub_u32 s14, s76, s77
    s_mov_b32 s15, s14
    s_mul_i32 s77, s13, 80
    v_lshrrev_b32 v24, 4, v1
    v_xor_b32 v25, v24, v1
    v_and_b32 v25, 15, v25
    v_lshlrev_b32 v25, 4, v25
    v_add_u32 v24, s77, v24
    v_mul_u32_u24 v26, 3072, v24
    v_add_u32 v26, v26, v25
    v_add_u32 v113, 0xc00000, v26
    v_lshrrev_b32 v24, 4, v1
    v_add_u32 v24, 4, v24
    v_xor_b32 v25, v24, v1
    v_and_b32 v25, 15, v25
    v_lshlrev_b32 v25, 4, v25
    v_add_u32 v24, s77, v24
    v_mul_u32_u24 v26, 3072, v24
    v_add_u32 v26, v26, v25
    v_add_u32 v151, 0xc00000, v26
    v_lshrrev_b32 v24, 4, v1
    v_add_u32 v24, 8, v24
    v_xor_b32 v25, v24, v1
    v_and_b32 v25, 15, v25
    v_lshlrev_b32 v25, 4, v25
    v_add_u32 v24, s77, v24
    v_mul_u32_u24 v26, 3072, v24
    v_add_u32 v26, v26, v25
    v_add_u32 v22, 0xc00000, v26
    v_lshrrev_b32 v24, 4, v1
    v_add_u32 v24, 12, v24
    v_xor_b32 v25, v24, v1
    v_and_b32 v25, 15, v25
    v_lshlrev_b32 v25, 4, v25
    v_add_u32 v24, s77, v24
    v_mul_u32_u24 v26, 3072, v24
    v_add_u32 v26, v26, v25
    v_add_u32 v23, 0xc00000, v26
    v_lshrrev_b32 v24, 4, v1
    v_add_u32 v24, 16, v24
    v_xor_b32 v25, v24, v1
    v_and_b32 v25, 15, v25
    v_lshlrev_b32 v25, 4, v25
    v_add_u32 v24, s77, v24
    v_mul_u32_u24 v26, 3072, v24
    v_add_u32 v26, v26, v25
    v_add_u32 v33, 0xc00000, v26
    s_lshr_b32 s76, s12, 1
    s_lshl_b32 s76, s76, 11
    s_add_u32 s76, s76, 0xb40000
    v_lshrrev_b32 v149, 2, v1
    v_lshlrev_b32 v149, 7, v149
    v_and_b32 v150, 3, v1
    v_lshl_add_u32 v149, v150, 2, v149
    v_add_u32 v149, s76, v149
    v_add_u32 v150, 16, v149
    s_mov_b32 s72, 0
k1_lloop:
    s_waitcnt vmcnt(10)
    s_barrier
    s_add_u32 s76, s67, s73
    s_add_u32 m0, s76, 0
    s_nop 0
    buffer_load_dwordx4 v2, s[40:43], s70 offen lds
    s_add_u32 s76, s67, s73
    s_add_u32 m0, s76, 1024
    s_nop 0
    buffer_load_dwordx4 v3, s[40:43], s70 offen lds
    s_add_u32 s76, s67, s73
    s_add_u32 m0, s76, 2048
    s_nop 0
    buffer_load_dwordx4 v4, s[40:43], s70 offen lds
    s_add_u32 s76, s67, s73
    s_add_u32 m0, s76, 3072
    s_nop 0
    buffer_load_dwordx4 v5, s[40:43], s70 offen lds
    s_add_u32 s76, s69, s73
    s_add_u32 m0, s76, 0
    s_nop 0
    buffer_load_dwordx4 v9, s[48:51], s71 offen lds
    s_add_u32 s76, s69, s73
    s_add_u32 m0, s76, 1024
    s_nop 0
    buffer_load_dwordx4 v10, s[48:51], s71 offen lds
    s_add_u32 s76, s69, s73
    s_add_u32 m0, s76, 2048
    s_nop 0
    buffer_load_dwordx4 v11, s[48:51], s71 offen lds
    s_add_u32 s76, s68, s73
    s_add_u32 m0, s76, 0
    s_nop 0
    buffer_load_dwordx4 v6, s[44:47], s70 offen lds
    s_add_u32 s76, s68, s73
    s_add_u32 m0, s76, 1024
    s_nop 0
    buffer_load_dwordx4 v7, s[44:47], s70 offen lds
    s_add_u32 s76, s68, s73
    s_add_u32 m0, s76, 2048
    s_mov_b64 exec, 0xffffffff
    buffer_load_dwordx4 v8, s[44:47], s70 offen lds
    s_mov_b64 exec, -1
    s_add_u32 s70, s70, 128
    s_add_u32 s71, s71, 196608
    s_cmp_ge_u32 s70, 1280
    s_cselect_b32 s70, 0, s70
    s_cselect_b32 s71, 0, s71
    s_add_u32 s73, s73, 38912
    s_cmp_ge_u32 s73, 116736
    s_cselect_b32 s73, 0, s73
    s_cmp_eq_u32 s72, 1
    s_cbranch_scc0 k1_l_no4
    s_cmp_eq_u32 s66, 0
    s_cbranch_scc0 k1_c_notw0
    v_lshlrev_b32 v30, 16, v30
    v_lshlrev_b32 v31, 16, v31
    v_lshlrev_b32 v32, 16, v32
    s_mov_b32 s76, 0x3fb8aa3b
    s_mov_b32 s77, 0x3e22f983
    v_mul_f32 v32, s76, v32
    v_exp_f32 v32, v32
    s_nop 0
    v_cvt_pk_bf16_f32 v32, v32, v32
    v_lshlrev_b32 v32, 16, v32
    v_mul_f32 v34, v32, v30
    v_mul_f32 v35, v32, v31
    v_mul_f32 v34, s76, v34
    v_exp_f32 v34, v34
    v_mul_f32 v35, s77, v35
    v_fract_f32 v35, v35
    v_cos_f32 v36, v35
    v_sin_f32 v37, v35
    s_nop 0
    v_mul_f32 v38, v34, v36
    v_mul_f32 v39, v34, v37
    v_mul_f32 v46, v30, v30
    v_fmac_f32 v46, v31, v31
    v_rcp_f32 v47, v46
    s_nop 0
    v_fma_f32 v48, -v46, v47, 1.0
    v_fmac_f32 v47, v48, v47
    v_add_f32 v48, -1.0, v38
    v_mul_f32 v40, v48, v30
    v_fmac_f32 v40, v39, v31
    v_mul_f32 v40, v40, v47
    v_mul_f32 v41, v39, v30
    v_fma_f32 v41, -v48, v31, v41
    v_mul_f32 v41, v41, v47
    v_mul_f32 v49, v39, v39
    v_fma_f32 v42, v38, v38, -v49
    v_mul_f32 v49, v38, v39
    v_add_f32 v43, v49, v49
    v_mul_f32 v49, v43, v43
    v_fma_f32 v50, v42, v42, -v49
    v_mul_f32 v49, v42, v43
    v_add_f32 v43, v49, v49
    v_mov_b32 v42, v50
    v_mul_f32 v49, v43, v43
    v_fma_f32 v50, v42, v42, -v49
    v_mul_f32 v49, v42, v43
    v_add_f32 v43, v49, v49
    v_mov_b32 v42, v50
    v_mul_f32 v49, v43, v43
    v_fma_f32 v44, v42, v42, -v49
    v_mul_f32 v49, v42, v43
    v_add_f32 v45, v49, v49
    v_mul_f32 v49, v45, v45
    v_fma_f32 v50, v44, v44, -v49
    v_mul_f32 v49, v44, v45
    v_add_f32 v45, v49, v49
    v_mov_b32 v44, v50
    v_mul_f32 v49, v45, v45
    v_fma_f32 v50, v44, v44, -v49
    v_mul_f32 v49, v44, v45
    v_add_f32 v45, v49, v49
    v_mov_b32 v44, v50
    v_mul_f32 v49, v45, v45
    v_fma_f32 v50, v44, v44, -v49
    v_mul_f32 v49, v44, v45
    v_add_f32 v45, v49, v49
    v_mov_b32 v44, v50
    v_lshlrev_b32 v49, 5, v1
    v_add_u32 v49, 156672, v49
    v_cmp_gt_u32 vcc, 40, v1
    s_and_saveexec_b64 s[78:79], vcc
    ds_write_b128 v49, v[38:41]
    ds_write_b128 v49, v[42:45] offset:16
    s_mov_b64 exec, s[78:79]
    v_mov_b32 v49, 157952
    v_mov_b32 v50, 0
    ds_write_b32 v49, v50
    ds_write_b32 v49, v50 offset:4
k1_c_notw0:
k1_l_no4:
    s_add_u32 s72, s72, 1
    s_cmp_lt_u32 s72, 7
    s_cbranch_scc1 k1_lloop
    s_cmp_eq_u32 s66, 3
    s_cbranch_scc0 k1_noct
    s_lshr_b32 s76, s2, 3
    s_mul_i32 s76, s76, 25600
    v_lshlrev_b32 v24, 7, v1
    v_add_u32 v24, s76, v24
    global_load_dword v38, v24, s[4:5] offset:0
    v_add_u32 v25, 8192, v24
    global_load_dword v39, v25, s[4:5]
    v_add_u32 v25, 16384, v24
    global_load_dword v40, v25, s[4:5]
    s_mov_b64 exec, 0xff
    v_add_u32 v25, 24576, v24
    global_load_dword v41, v25, s[4:5]
    s_mov_b64 exec, -1
    global_load_dword v40, v24, s[6:7] offset:0
    v_add_u32 v25, 8192, v24
    global_load_dword v41, v25, s[6:7]
    v_add_u32 v25, 16384, v24
    global_load_dword v42, v25, s[6:7]
    s_mov_b64 exec, 0xff
    v_add_u32 v25, 24576, v24
    global_load_dword v43, v25, s[6:7]
    s_mov_b64 exec, -1
k1_noct:
    s_waitcnt vmcnt(10) lgkmcnt(0)
    s_barrier
    s_waitcnt vmcnt(0)
    s_barrier
    s_cmp_eq_u32 s66, 0
    s_cbranch_scc1 k1_chainwave
    s_barrier
    s_setprio 0
    s_cmp_ge_u32 s66, 2
    s_cbranch_scc0 k1_g_skip
    v_mov_b32 v34, 0
    v_lshlrev_b32 v35, 16, v64
    v_and_b32 v36, 0xffff0000, v64
    v_lshlrev_b32 v37, 16, v84
    v_and_b32 v38, 0xffff0000, v84
    v_mul_f32 v35, v35, v37
    v_mul_f32 v36, v36, v38
    v_cvt_pk_bf16_f32 v35, v35, v36
    v_lshlrev_b32 v36, 16, v35
    v_and_b32 v35, 0xffff0000, v35
    v_add_f32 v34, v34, v36
    v_add_f32 v34, v34, v35
    v_lshlrev_b32 v35, 16, v65
    v_and_b32 v36, 0xffff0000, v65
    v_lshlrev_b32 v37, 16, v85
    v_and_b32 v38, 0xffff0000, v85
    v_mul_f32 v35, v35, v37
    v_mul_f32 v36, v36, v38
    v_cvt_pk_bf16_f32 v35, v35, v36
    v_lshlrev_b32 v36, 16, v35
    v_and_b32 v35, 0xffff0000, v35
    v_add_f32 v34, v34, v36
    v_add_f32 v34, v34, v35
    v_lshlrev_b32 v35, 16, v66
    v_and_b32 v36, 0xffff0000, v66
    v_lshlrev_b32 v37, 16, v86
    v_and_b32 v38, 0xffff0000, v86
    v_mul_f32 v35, v35, v37
    v_mul_f32 v36, v36, v38
    v_cvt_pk_bf16_f32 v35, v35, v36
    v_lshlrev_b32 v36, 16, v35
    v_and_b32 v35, 0xffff0000, v35
    v_add_f32 v34, v34, v36
    v_add_f32 v34, v34, v35
    v_lshlrev_b32 v35, 16, v67
    v_and_b32 v36, 0xffff0000, v67
    v_lshlrev_b32 v37, 16, v87
    v_and_b32 v38, 0xffff0000, v87
    v_mul_f32 v35, v35, v37
    v_mul_f32 v36, v36, v38
    v_cvt_pk_bf16_f32 v35, v35, v36
    v_lshlrev_b32 v36, 16, v35
    v_and_b32 v35, 0xffff0000, v35
    v_add_f32 v34, v34, v36
    v_add_f32 v34, v34, v35
    v_lshlrev_b32 v35, 16, v68
    v_and_b32 v36, 0xffff0000, v68
    v_lshlrev_b32 v37, 16, v88
    v_and_b32 v38, 0xffff0000, v88
    v_mul_f32 v35, v35, v37
    v_mul_f32 v36, v36, v38
    v_cvt_pk_bf16_f32 v35, v35, v36
    v_lshlrev_b32 v36, 16, v35
    v_and_b32 v35, 0xffff0000, v35
    v_add_f32 v34, v34, v36
    v_add_f32 v34, v34, v35
    v_lshlrev_b32 v35, 16, v69
    v_and_b32 v36, 0xffff0000, v69
    v_lshlrev_b32 v37, 16, v89
    v_and_b32 v38, 0xffff0000, v89
    v_mul_f32 v35, v35, v37
    v_mul_f32 v36, v36, v38
    v_cvt_pk_bf16_f32 v35, v35, v36
    v_lshlrev_b32 v36, 16, v35
    v_and_b32 v35, 0xffff0000, v35
    v_add_f32 v34, v34, v36
    v_add_f32 v34, v34, v35
    v_lshlrev_b32 v35, 16, v70
    v_and_b32 v36, 0xffff0000, v70
    v_lshlrev_b32 v37, 16, v90
    v_and_b32 v38, 0xffff0000, v90
    v_mul_f32 v35, v35, v37
    v_mul_f32 v36, v36, v38
    v_cvt_pk_bf16_f32 v35, v35, v36
    v_lshlrev_b32 v36, 16, v35
    v_and_b32 v35, 0xffff0000, v35
    v_add_f32 v34, v34, v36
    v_add_f32 v34, v34, v35
    v_lshlrev_b32 v35, 16, v71
    v_and_b32 v36, 0xffff0000, v71
    v_lshlrev_b32 v37, 16, v91
    v_and_b32 v38, 0xffff0000, v91
    v_mul_f32 v35, v35, v37
    v_mul_f32 v36, v36, v38
    v_cvt_pk_bf16_f32 v35, v35, v36
    v_lshlrev_b32 v36, 16, v35
    v_and_b32 v35, 0xffff0000, v35
    v_add_f32 v34, v34, v36
    v_add_f32 v34, v34, v35
    v_lshlrev_b32 v35, 16, v72
    v_and_b32 v36, 0xffff0000, v72
    v_lshlrev_b32 v37, 16, v92
    v_and_b32 v38, 0xffff0000, v92
    v_mul_f32 v35, v35, v37
    v_mul_f32 v36, v36, v38
    v_cvt_pk_bf16_f32 v35, v35, v36
    v_lshlrev_b32 v36, 16, v35
    v_and_b32 v35, 0xffff0000, v35
    v_add_f32 v34, v34, v36
    v_add_f32 v34, v34, v35
    v_lshlrev_b32 v35, 16, v73
    v_and_b32 v36, 0xffff0000, v73
    v_lshlrev_b32 v37, 16, v93
    v_and_b32 v38, 0xffff0000, v93
    v_mul_f32 v35, v35, v37
    v_mul_f32 v36, v36, v38
    v_cvt_pk_bf16_f32 v35, v35, v36
    v_lshlrev_b32 v36, 16, v35
    v_and_b32 v35, 0xffff0000, v35
    v_add_f32 v34, v34, v36
    v_add_f32 v34, v34, v35
    v_lshlrev_b32 v35, 16, v74
    v_and_b32 v36, 0xffff0000, v74
    v_lshlrev_b32 v37, 16, v94
    v_and_b32 v38, 0xffff0000, v94
    v_mul_f32 v35, v35, v37
    v_mul_f32 v36, v36, v38
    v_cvt_pk_bf16_f32 v35, v35, v36
    v_lshlrev_b32 v36, 16, v35
    v_and_b32 v35, 0xffff0000, v35
    v_add_f32 v34, v34, v36
    v_add_f32 v34, v34, v35
    v_lshlrev_b32 v35, 16, v75
    v_and_b32 v36, 0xffff0000, v75
    v_lshlrev_b32 v37, 16, v95
    v_and_b32 v38, 0xffff0000, v95
    v_mul_f32 v35, v35, v37
    v_mul_f32 v36, v36, v38
    v_cvt_pk_bf16_f32 v35, v35, v36
    v_lshlrev_b32 v36, 16, v35
    v_and_b32 v35, 0xffff0000, v35
    v_add_f32 v34, v34, v36
    v_add_f32 v34, v34, v35
    v_lshlrev_b32 v35, 16, v76
    v_and_b32 v36, 0xffff0000, v76
    v_lshlrev_b32 v37, 16, v96
    v_and_b32 v38, 0xffff0000, v96
    v_mul_f32 v35, v35, v37
    v_mul_f32 v36, v36, v38
    v_cvt_pk_bf16_f32 v35, v35, v36
    v_lshlrev_b32 v36, 16, v35
    v_and_b32 v35, 0xffff0000, v35
    v_add_f32 v34, v34, v36
    v_add_f32 v34, v34, v35
    v_lshlrev_b32 v35, 16, v77
    v_and_b32 v36, 0xffff0000, v77
    v_lshlrev_b32 v37, 16, v97
    v_and_b32 v38, 0xffff0000, v97
    v_mul_f32 v35, v35, v37
    v_mul_f32 v36, v36, v38
    v_cvt_pk_bf16_f32 v35, v35, v36
    v_lshlrev_b32 v36, 16, v35
    v_and_b32 v35, 0xffff0000, v35
    v_add_f32 v34, v34, v36
    v_add_f32 v34, v34, v35
    v_lshlrev_b32 v35, 16, v78
    v_and_b32 v36, 0xffff0000, v78
    v_lshlrev_b32 v37, 16, v98
    v_and_b32 v38, 0xffff0000, v98
    v_mul_f32 v35, v35, v37
    v_mul_f32 v36, v36, v38
    v_cvt_pk_bf16_f32 v35, v35, v36
    v_lshlrev_b32 v36, 16, v35
    v_and_b32 v35, 0xffff0000, v35
    v_add_f32 v34, v34, v36
    v_add_f32 v34, v34, v35
    v_lshlrev_b32 v35, 16, v79
    v_and_b32 v36, 0xffff0000, v79
    v_lshlrev_b32 v37, 16, v99
    v_and_b32 v38, 0xffff0000, v99
    v_mul_f32 v35, v35, v37
    v_mul_f32 v36, v36, v38
    v_cvt_pk_bf16_f32 v35, v35, v36
    v_lshlrev_b32 v36, 16, v35
    v_and_b32 v35, 0xffff0000, v35
    v_add_f32 v34, v34, v36
    v_add_f32 v34, v34, v35
    v_lshlrev_b32 v35, 16, v80
    v_and_b32 v36, 0xffff0000, v80
    v_lshlrev_b32 v37, 16, v100
    v_and_b32 v38, 0xffff0000, v100
    v_mul_f32 v35, v35, v37
    v_mul_f32 v36, v36, v38
    v_cvt_pk_bf16_f32 v35, v35, v36
    v_lshlrev_b32 v36, 16, v35
    v_and_b32 v35, 0xffff0000, v35
    v_add_f32 v34, v34, v36
    v_add_f32 v34, v34, v35
    v_lshlrev_b32 v35, 16, v81
    v_and_b32 v36, 0xffff0000, v81
    v_lshlrev_b32 v37, 16, v101
    v_and_b32 v38, 0xffff0000, v101
    v_mul_f32 v35, v35, v37
    v_mul_f32 v36, v36, v38
    v_cvt_pk_bf16_f32 v35, v35, v36
    v_lshlrev_b32 v36, 16, v35
    v_and_b32 v35, 0xffff0000, v35
    v_add_f32 v34, v34, v36
    v_add_f32 v34, v34, v35
    v_lshlrev_b32 v35, 16, v82
    v_and_b32 v36, 0xffff0000, v82
    v_lshlrev_b32 v37, 16, v102
    v_and_b32 v38, 0xffff0000, v102
    v_mul_f32 v35, v35, v37
    v_mul_f32 v36, v36, v38
    v_cvt_pk_bf16_f32 v35, v35, v36
    v_lshlrev_b32 v36, 16, v35
    v_and_b32 v35, 0xffff0000, v35
    v_add_f32 v34, v34, v36
    v_add_f32 v34, v34, v35
    v_lshlrev_b32 v35, 16, v83
    v_and_b32 v36, 0xffff0000, v83
    v_lshlrev_b32 v37, 16, v103
    v_and_b32 v38, 0xffff0000, v103
    v_mul_f32 v35, v35, v37
    v_mul_f32 v36, v36, v38
    v_cvt_pk_bf16_f32 v35, v35, v36
    v_lshlrev_b32 v36, 16, v35
    v_and_b32 v35, 0xffff0000, v35
    v_add_f32 v34, v34, v36
    v_add_f32 v34, v34, v35
    s_nop 1
    v_add_f32_dpp v34, v34, v34 row_ror:8 row_mask:0xf bank_mask:0xf
    s_nop 1
    v_add_f32_dpp v34, v34, v34 row_ror:4 row_mask:0xf bank_mask:0xf
    s_nop 1
    v_add_f32_dpp v34, v34, v34 row_ror:2 row_mask:0xf bank_mask:0xf
    s_nop 1
    v_add_f32_dpp v34, v34, v34 row_ror:1 row_mask:0xf bank_mask:0xf
    s_nop 0
    v_cvt_pk_bf16_f32 v34, v34, v34
    v_lshlrev_b32 v34, 16, v34
    v_mul_f32 v34, 0xbfb8aa3b, v34
    v_exp_f32 v34, v34
    s_nop 0
    v_add_f32 v34, 1.0, v34
    v_rcp_f32 v34, v34
    s_nop 0
    v_cvt_pk_bf16_f32 v34, v34, v34
    v_lshlrev_b32 v34, 16, v34
    v_subrev_u32 v35, 384, v0
    v_lshrrev_b32 v35, 4, v35
    s_lshl_b32 s76, s64, 7
    s_lshl_b32 s77, s65, 3
    s_add_u32 s76, s76, s77
    v_add_u32 v35, s76, v35
    v_lshlrev_b32 v35, 2, v35
    v_add_u32 v35, 0xb00000, v35
    v_and_b32 v36, 15, v1
    v_cmp_eq_u32 vcc, 0, v36
    s_and_saveexec_b64 s[78:79], vcc
    buffer_store_dword v34, v35, s[52:55], 0 offen sc1
    s_mov_b64 exec, s[78:79]
k1_g_skip:
    v_lshlrev_b32 v25, 2, v1
    s_mov_b32 s81, 0
k_ac_a:
    buffer_load_dword v24, v25, s[56:59], 0 offen sc1
    s_waitcnt vmcnt(0)
    v_cmp_eq_u32 vcc, 0x01010101, v24
    s_cmp_eq_u64 vcc, -1
    s_cbranch_scc1 k_acd_a
    s_sleep 8
    s_add_u32 s81, s81, 1
    s_cmp_lt_u32 s81, 0x80000
    s_cbranch_scc1 k_ac_a
k_acd_a:
    s_setprio 3
    s_branch k2_lsetup
k1_chainwave:
    s_setprio 3
    v_mov_b32 v2, v1
    v_add_u32 v3, 64, v1
    v_min_u32 v3, 79, v3
    v_lshrrev_b32 v24, 1, v2
    v_lshlrev_b32 v24, 5, v24
    v_add_u32 v24, 156672, v24
    ds_read_b128 v[96:99], v24 offset:16
    v_lshlrev_b32 v16, 2, v2
    v_add_u32 v16, 151552, v16
    v_lshrrev_b32 v24, 1, v3
    v_lshlrev_b32 v24, 5, v24
    v_add_u32 v24, 156672, v24
    ds_read_b128 v[100:103], v24 offset:16
    v_lshlrev_b32 v17, 2, v3
    v_add_u32 v17, 151552, v17
    v_and_b32 v25, 1, v1
    v_cmp_eq_u32 vcc, 1, v25
    s_waitcnt lgkmcnt(0)
    v_mov_b32 v8, v96
    v_sub_f32 v26, 0, v97
    v_cndmask_b32 v10, v26, v97, vcc
    v_mov_b32 v12, v98
    v_sub_f32 v26, 0, v99
    v_cndmask_b32 v14, v26, v99, vcc
    v_mov_b32 v9, v100
    v_sub_f32 v26, 0, v101
    v_cndmask_b32 v11, v26, v101, vcc
    v_mov_b32 v13, v102
    v_sub_f32 v26, 0, v103
    v_cndmask_b32 v15, v26, v103, vcc
    s_barrier
    ds_read_b32 v64, v16 offset:0
    ds_read_b32 v80, v17 offset:0
    ds_read_b32 v65, v16 offset:320
    ds_read_b32 v81, v17 offset:320
    ds_read_b32 v66, v16 offset:640
    ds_read_b32 v82, v17 offset:640
    ds_read_b32 v67, v16 offset:960
    ds_read_b32 v83, v17 offset:960
    ds_read_b32 v68, v16 offset:1280
    ds_read_b32 v84, v17 offset:1280
    ds_read_b32 v69, v16 offset:1600
    ds_read_b32 v85, v17 offset:1600
    ds_read_b32 v70, v16 offset:1920
    ds_read_b32 v86, v17 offset:1920
    s_waitcnt lgkmcnt(0)
    ds_read_b32 v71, v16 offset:2240
    ds_read_b32 v87, v17 offset:2240
    ds_read_b32 v72, v16 offset:2560
    ds_read_b32 v88, v17 offset:2560
    ds_read_b32 v73, v16 offset:2880
    ds_read_b32 v89, v17 offset:2880
    ds_read_b32 v74, v16 offset:3200
    ds_read_b32 v90, v17 offset:3200
    ds_read_b32 v75, v16 offset:3520
    ds_read_b32 v91, v17 offset:3520
    ds_read_b32 v76, v16 offset:3840
    ds_read_b32 v92, v17 offset:3840
    ds_read_b32 v77, v16 offset:4160
    ds_read_b32 v93, v17 offset:4160
    s_waitcnt lgkmcnt(0)
    ds_read_b32 v78, v16 offset:4480
    ds_read_b32 v94, v17 offset:4480
    ds_read_b32 v79, v16 offset:4800
    ds_read_b32 v95, v17 offset:4800
    s_waitcnt lgkmcnt(0)
    v_mov_b32 v4, v64
    v_mov_b32 v5, v80
    s_nop 0
    v_fma_f32 v6, v8, v4, v65
    v_fma_f32 v7, v9, v5, v81
    v_fmac_f32_dpp v6, v4, v10 quad_perm:[1,0,3,2] row_mask:0xf bank_mask:0xf
    v_fmac_f32_dpp v7, v5, v11 quad_perm:[1,0,3,2] row_mask:0xf bank_mask:0xf
    v_mov_b32 v4, v6
    v_mov_b32 v5, v7
    v_fma_f32 v6, v8, v4, v66
    v_fma_f32 v7, v9, v5, v82
    v_fmac_f32_dpp v6, v4, v10 quad_perm:[1,0,3,2] row_mask:0xf bank_mask:0xf
    v_fmac_f32_dpp v7, v5, v11 quad_perm:[1,0,3,2] row_mask:0xf bank_mask:0xf
    v_mov_b32 v4, v6
    v_mov_b32 v5, v7
    v_fma_f32 v6, v8, v4, v67
    v_fma_f32 v7, v9, v5, v83
    v_fmac_f32_dpp v6, v4, v10 quad_perm:[1,0,3,2] row_mask:0xf bank_mask:0xf
    v_fmac_f32_dpp v7, v5, v11 quad_perm:[1,0,3,2] row_mask:0xf bank_mask:0xf
    v_mov_b32 v4, v6
    v_mov_b32 v5, v7
    v_fma_f32 v6, v8, v4, v68
    v_fma_f32 v7, v9, v5, v84
    v_fmac_f32_dpp v6, v4, v10 quad_perm:[1,0,3,2] row_mask:0xf bank_mask:0xf
    v_fmac_f32_dpp v7, v5, v11 quad_perm:[1,0,3,2] row_mask:0xf bank_mask:0xf
    v_mov_b32 v4, v6
    v_mov_b32 v5, v7
    v_fma_f32 v6, v8, v4, v69
    v_fma_f32 v7, v9, v5, v85
    v_fmac_f32_dpp v6, v4, v10 quad_perm:[1,0,3,2] row_mask:0xf bank_mask:0xf
    v_fmac_f32_dpp v7, v5, v11 quad_perm:[1,0,3,2] row_mask:0xf bank_mask:0xf
    v_mov_b32 v4, v6
    v_mov_b32 v5, v7
    v_fma_f32 v6, v8, v4, v70
    v_fma_f32 v7, v9, v5, v86
    v_fmac_f32_dpp v6, v4, v10 quad_perm:[1,0,3,2] row_mask:0xf bank_mask:0xf
    v_fmac_f32_dpp v7, v5, v11 quad_perm:[1,0,3,2] row_mask:0xf bank_mask:0xf
    v_mov_b32 v4, v6
    v_mov_b32 v5, v7
    v_fma_f32 v6, v8, v4, v71
    v_fma_f32 v7, v9, v5, v87
    v_fmac_f32_dpp v6, v4, v10 quad_perm:[1,0,3,2] row_mask:0xf bank_mask:0xf
    v_fmac_f32_dpp v7, v5, v11 quad_perm:[1,0,3,2] row_mask:0xf bank_mask:0xf
    v_mov_b32 v4, v6
    v_mov_b32 v5, v7
    v_fma_f32 v6, v8, v4, v72
    v_fma_f32 v7, v9, v5, v88
    v_fmac_f32_dpp v6, v4, v10 quad_perm:[1,0,3,2] row_mask:0xf bank_mask:0xf
    v_fmac_f32_dpp v7, v5, v11 quad_perm:[1,0,3,2] row_mask:0xf bank_mask:0xf
    v_mov_b32 v4, v6
    v_mov_b32 v5, v7
    v_fma_f32 v6, v8, v4, v73
    v_fma_f32 v7, v9, v5, v89
    v_fmac_f32_dpp v6, v4, v10 quad_perm:[1,0,3,2] row_mask:0xf bank_mask:0xf
    v_fmac_f32_dpp v7, v5, v11 quad_perm:[1,0,3,2] row_mask:0xf bank_mask:0xf
    v_mov_b32 v4, v6
    v_mov_b32 v5, v7
    v_fma_f32 v6, v8, v4, v74
    v_fma_f32 v7, v9, v5, v90
    v_fmac_f32_dpp v6, v4, v10 quad_perm:[1,0,3,2] row_mask:0xf bank_mask:0xf
    v_fmac_f32_dpp v7, v5, v11 quad_perm:[1,0,3,2] row_mask:0xf bank_mask:0xf
    v_mov_b32 v4, v6
    v_mov_b32 v5, v7
    v_fma_f32 v6, v8, v4, v75
    v_fma_f32 v7, v9, v5, v91
    v_fmac_f32_dpp v6, v4, v10 quad_perm:[1,0,3,2] row_mask:0xf bank_mask:0xf
    v_fmac_f32_dpp v7, v5, v11 quad_perm:[1,0,3,2] row_mask:0xf bank_mask:0xf
    v_mov_b32 v4, v6
    v_mov_b32 v5, v7
    v_fma_f32 v6, v8, v4, v76
    v_fma_f32 v7, v9, v5, v92
    v_fmac_f32_dpp v6, v4, v10 quad_perm:[1,0,3,2] row_mask:0xf bank_mask:0xf
    v_fmac_f32_dpp v7, v5, v11 quad_perm:[1,0,3,2] row_mask:0xf bank_mask:0xf
    v_mov_b32 v4, v6
    v_mov_b32 v5, v7
    v_fma_f32 v6, v8, v4, v77
    v_fma_f32 v7, v9, v5, v93
    v_fmac_f32_dpp v6, v4, v10 quad_perm:[1,0,3,2] row_mask:0xf bank_mask:0xf
    v_fmac_f32_dpp v7, v5, v11 quad_perm:[1,0,3,2] row_mask:0xf bank_mask:0xf
    v_mov_b32 v4, v6
    v_mov_b32 v5, v7
    v_fma_f32 v6, v8, v4, v78
    v_fma_f32 v7, v9, v5, v94
    v_fmac_f32_dpp v6, v4, v10 quad_perm:[1,0,3,2] row_mask:0xf bank_mask:0xf
    v_fmac_f32_dpp v7, v5, v11 quad_perm:[1,0,3,2] row_mask:0xf bank_mask:0xf
    v_mov_b32 v4, v6
    v_mov_b32 v5, v7
    v_fma_f32 v6, v8, v4, v79
    v_fma_f32 v7, v9, v5, v95
    v_fmac_f32_dpp v6, v4, v10 quad_perm:[1,0,3,2] row_mask:0xf bank_mask:0xf
    v_fmac_f32_dpp v7, v5, v11 quad_perm:[1,0,3,2] row_mask:0xf bank_mask:0xf
    v_mov_b32 v4, v6
    v_mov_b32 v5, v7
    s_lshl_b32 s76, s64, 4
    s_add_u32 s76, s76, s65
    s_mul_i32 s76, s76, 640
    s_add_u32 s76, s76, 0xb02000
    v_lshlrev_b32 v24, 3, v1
    v_mov_b32 v18, v4
    v_mov_b32 v19, 1
    v_mov_b32 v20, v5
    v_mov_b32 v21, 1
    buffer_store_dwordx2 v[18:19], v24, s[52:55], s76 offen sc1
    s_mov_b64 exec, 0xffff
    buffer_store_dwordx2 v[20:21], v24, s[52:55], s76 offen offset:512 sc1
    s_mov_b64 exec, -1
    v_lshlrev_b32 v25, 2, v1
    s_mov_b32 s81, 0
k_ac_b:
    buffer_load_dword v24, v25, s[56:59], 0 offen sc1
    s_waitcnt vmcnt(0)
    v_cmp_eq_u32 vcc, 0x01010101, v24
    s_cmp_eq_u64 vcc, -1
    s_cbranch_scc1 k_acd_b
    s_sleep 8
    s_add_u32 s81, s81, 1
    s_cmp_lt_u32 s81, 0x80000
    s_cbranch_scc1 k_ac_b
k_acd_b:
    v_mov_b32 v4, 0
    v_mov_b32 v5, 0
    s_cmp_eq_u32 s64, 0
    s_cbranch_scc1 k1_e5_chain2
    v_lshlrev_b32 v24, 3, v2
    v_lshlrev_b32 v25, 3, v3
    s_mov_b32 s81, 0
k1_poll:
    s_mul_i32 s76, s65, 640
    s_add_u32 s76, s76, 0xb02000
    buffer_load_dwordx2 v[34:35], v24, s[52:55], s76 offen sc1
    buffer_load_dwordx2 v[114:115], v25, s[52:55], s76 offen sc1
    s_add_u32 s76, s76, 10240
    s_cmp_eq_u32 s64, 1
    s_cbranch_scc1 k1_poll_w
    buffer_load_dwordx2 v[36:37], v24, s[52:55], s76 offen sc1
    buffer_load_dwordx2 v[116:117], v25, s[52:55], s76 offen sc1
    s_add_u32 s76, s76, 10240
    s_cmp_eq_u32 s64, 2
    s_cbranch_scc1 k1_poll_w
    buffer_load_dwordx2 v[38:39], v24, s[52:55], s76 offen sc1
    buffer_load_dwordx2 v[118:119], v25, s[52:55], s76 offen sc1
    s_add_u32 s76, s76, 10240
    s_cmp_eq_u32 s64, 3
    s_cbranch_scc1 k1_poll_w
    buffer_load_dwordx2 v[40:41], v24, s[52:55], s76 offen sc1
    buffer_load_dwordx2 v[120:121], v25, s[52:55], s76 offen sc1
    s_add_u32 s76, s76, 10240
    s_cmp_eq_u32 s64, 4
    s_cbranch_scc1 k1_poll_w
    buffer_load_dwordx2 v[42:43], v24, s[52:55], s76 offen sc1
    buffer_load_dwordx2 v[122:123], v25, s[52:55], s76 offen sc1
    s_add_u32 s76, s76, 10240
    s_cmp_eq_u32 s64, 5
    s_cbranch_scc1 k1_poll_w
    buffer_load_dwordx2 v[44:45], v24, s[52:55], s76 offen sc1
    buffer_load_dwordx2 v[124:125], v25, s[52:55], s76 offen sc1
    s_add_u32 s76, s76, 10240
    s_cmp_eq_u32 s64, 6
    s_cbranch_scc1 k1_poll_w
    buffer_load_dwordx2 v[46:47], v24, s[52:55], s76 offen sc1
    buffer_load_dwordx2 v[126:127], v25, s[52:55], s76 offen sc1
    s_add_u32 s76, s76, 10240
    s_cmp_eq_u32 s64, 7
    s_cbranch_scc1 k1_poll_w
    buffer_load_dwordx2 v[48:49], v24, s[52:55], s76 offen sc1
    buffer_load_dwordx2 v[128:129], v25, s[52:55], s76 offen sc1
    s_add_u32 s76, s76, 10240
    s_cmp_eq_u32 s64, 8
    s_cbranch_scc1 k1_poll_w
    buffer_load_dwordx2 v[50:51], v24, s[52:55], s76 offen sc1
    buffer_load_dwordx2 v[130:131], v25, s[52:55], s76 offen sc1
    s_add_u32 s76, s76, 10240
    s_cmp_eq_u32 s64, 9
    s_cbranch_scc1 k1_poll_w
    buffer_load_dwordx2 v[52:53], v24, s[52:55], s76 offen sc1
    buffer_load_dwordx2 v[132:133], v25, s[52:55], s76 offen sc1
    s_add_u32 s76, s76, 10240
    s_cmp_eq_u32 s64, 10
    s_cbranch_scc1 k1_poll_w
    buffer_load_dwordx2 v[54:55], v24, s[52:55], s76 offen sc1
    buffer_load_dwordx2 v[134:135], v25, s[52:55], s76 offen sc1
    s_add_u32 s76, s76, 10240
    s_cmp_eq_u32 s64, 11
    s_cbranch_scc1 k1_poll_w
    buffer_load_dwordx2 v[56:57], v24, s[52:55], s76 offen sc1
    buffer_load_dwordx2 v[136:137], v25, s[52:55], s76 offen sc1
    s_add_u32 s76, s76, 10240
    s_cmp_eq_u32 s64, 12
    s_cbranch_scc1 k1_poll_w
    buffer_load_dwordx2 v[58:59], v24, s[52:55], s76 offen sc1
    buffer_load_dwordx2 v[138:139], v25, s[52:55], s76 offen sc1
    s_add_u32 s76, s76, 10240
    s_cmp_eq_u32 s64, 13
    s_cbranch_scc1 k1_poll_w
    buffer_load_dwordx2 v[60:61], v24, s[52:55], s76 offen sc1
    buffer_load_dwordx2 v[140:141], v25, s[52:55], s76 offen sc1
    s_add_u32 s76, s76, 10240
    s_cmp_eq_u32 s64, 14
    s_cbranch_scc1 k1_poll_w
    buffer_load_dwordx2 v[62:63], v24, s[52:55], s76 offen sc1
    buffer_load_dwordx2 v[142:143], v25, s[52:55], s76 offen sc1
k1_poll_w:
    s_waitcnt vmcnt(0)
    v_mov_b32 v26, 1
    v_and_b32 v26, v26, v35
    v_and_b32 v26, v26, v115
    s_cmp_eq_u32 s64, 1
    s_cbranch_scc1 k1_poll_c
    v_and_b32 v26, v26, v37
    v_and_b32 v26, v26, v117
    s_cmp_eq_u32 s64, 2
    s_cbranch_scc1 k1_poll_c
    v_and_b32 v26, v26, v39
    v_and_b32 v26, v26, v119
    s_cmp_eq_u32 s64, 3
    s_cbranch_scc1 k1_poll_c
    v_and_b32 v26, v26, v41
    v_and_b32 v26, v26, v121
    s_cmp_eq_u32 s64, 4
    s_cbranch_scc1 k1_poll_c
    v_and_b32 v26, v26, v43
    v_and_b32 v26, v26, v123
    s_cmp_eq_u32 s64, 5
    s_cbranch_scc1 k1_poll_c
    v_and_b32 v26, v26, v45
    v_and_b32 v26, v26, v125
    s_cmp_eq_u32 s64, 6
    s_cbranch_scc1 k1_poll_c
    v_and_b32 v26, v26, v47
    v_and_b32 v26, v26, v127
    s_cmp_eq_u32 s64, 7
    s_cbranch_scc1 k1_poll_c
    v_and_b32 v26, v26, v49
    v_and_b32 v26, v26, v129
    s_cmp_eq_u32 s64, 8
    s_cbranch_scc1 k1_poll_c
    v_and_b32 v26, v26, v51
    v_and_b32 v26, v26, v131
    s_cmp_eq_u32 s64, 9
    s_cbranch_scc1 k1_poll_c
    v_and_b32 v26, v26, v53
    v_and_b32 v26, v26, v133
    s_cmp_eq_u32 s64, 10
    s_cbranch_scc1 k1_poll_c
    v_and_b32 v26, v26, v55
    v_and_b32 v26, v26, v135
    s_cmp_eq_u32 s64, 11
    s_cbranch_scc1 k1_poll_c
    v_and_b32 v26, v26, v57
    v_and_b32 v26, v26, v137
    s_cmp_eq_u32 s64, 12
    s_cbranch_scc1 k1_poll_c
    v_and_b32 v26, v26, v59
    v_and_b32 v26, v26, v139
    s_cmp_eq_u32 s64, 13
    s_cbranch_scc1 k1_poll_c
    v_and_b32 v26, v26, v61
    v_and_b32 v26, v26, v141
    s_cmp_eq_u32 s64, 14
    s_cbranch_scc1 k1_poll_c
    v_and_b32 v26, v26, v63
    v_and_b32 v26, v26, v143
k1_poll_c:
    v_cmp_eq_u32 vcc, 1, v26
    s_cmp_eq_u64 vcc, -1
    s_cbranch_scc1 k1_poll_done
    s_add_u32 s81, s81, 1
    s_cmp_lt_u32 s81, 0x40000
    s_cbranch_scc1 k1_poll
k1_poll_done:
    v_fma_f32 v6, v12, v4, v34
    v_fma_f32 v7, v13, v5, v114
    v_fmac_f32_dpp v6, v4, v14 quad_perm:[1,0,3,2] row_mask:0xf bank_mask:0xf
    v_fmac_f32_dpp v7, v5, v15 quad_perm:[1,0,3,2] row_mask:0xf bank_mask:0xf
    v_mov_b32 v4, v6
    v_mov_b32 v5, v7
    s_cmp_eq_u32 s64, 1
    s_cbranch_scc1 k1_e5_chain2
    v_fma_f32 v6, v12, v4, v36
    v_fma_f32 v7, v13, v5, v116
    v_fmac_f32_dpp v6, v4, v14 quad_perm:[1,0,3,2] row_mask:0xf bank_mask:0xf
    v_fmac_f32_dpp v7, v5, v15 quad_perm:[1,0,3,2] row_mask:0xf bank_mask:0xf
    v_mov_b32 v4, v6
    v_mov_b32 v5, v7
    s_cmp_eq_u32 s64, 2
    s_cbranch_scc1 k1_e5_chain2
    v_fma_f32 v6, v12, v4, v38
    v_fma_f32 v7, v13, v5, v118
    v_fmac_f32_dpp v6, v4, v14 quad_perm:[1,0,3,2] row_mask:0xf bank_mask:0xf
    v_fmac_f32_dpp v7, v5, v15 quad_perm:[1,0,3,2] row_mask:0xf bank_mask:0xf
    v_mov_b32 v4, v6
    v_mov_b32 v5, v7
    s_cmp_eq_u32 s64, 3
    s_cbranch_scc1 k1_e5_chain2
    v_fma_f32 v6, v12, v4, v40
    v_fma_f32 v7, v13, v5, v120
    v_fmac_f32_dpp v6, v4, v14 quad_perm:[1,0,3,2] row_mask:0xf bank_mask:0xf
    v_fmac_f32_dpp v7, v5, v15 quad_perm:[1,0,3,2] row_mask:0xf bank_mask:0xf
    v_mov_b32 v4, v6
    v_mov_b32 v5, v7
    s_cmp_eq_u32 s64, 4
    s_cbranch_scc1 k1_e5_chain2
    v_fma_f32 v6, v12, v4, v42
    v_fma_f32 v7, v13, v5, v122
    v_fmac_f32_dpp v6, v4, v14 quad_perm:[1,0,3,2] row_mask:0xf bank_mask:0xf
    v_fmac_f32_dpp v7, v5, v15 quad_perm:[1,0,3,2] row_mask:0xf bank_mask:0xf
    v_mov_b32 v4, v6
    v_mov_b32 v5, v7
    s_cmp_eq_u32 s64, 5
    s_cbranch_scc1 k1_e5_chain2
    v_fma_f32 v6, v12, v4, v44
    v_fma_f32 v7, v13, v5, v124
    v_fmac_f32_dpp v6, v4, v14 quad_perm:[1,0,3,2] row_mask:0xf bank_mask:0xf
    v_fmac_f32_dpp v7, v5, v15 quad_perm:[1,0,3,2] row_mask:0xf bank_mask:0xf
    v_mov_b32 v4, v6
    v_mov_b32 v5, v7
    s_cmp_eq_u32 s64, 6
    s_cbranch_scc1 k1_e5_chain2
    v_fma_f32 v6, v12, v4, v46
    v_fma_f32 v7, v13, v5, v126
    v_fmac_f32_dpp v6, v4, v14 quad_perm:[1,0,3,2] row_mask:0xf bank_mask:0xf
    v_fmac_f32_dpp v7, v5, v15 quad_perm:[1,0,3,2] row_mask:0xf bank_mask:0xf
    v_mov_b32 v4, v6
    v_mov_b32 v5, v7
    s_cmp_eq_u32 s64, 7
    s_cbranch_scc1 k1_e5_chain2
    v_fma_f32 v6, v12, v4, v48
    v_fma_f32 v7, v13, v5, v128
    v_fmac_f32_dpp v6, v4, v14 quad_perm:[1,0,3,2] row_mask:0xf bank_mask:0xf
    v_fmac_f32_dpp v7, v5, v15 quad_perm:[1,0,3,2] row_mask:0xf bank_mask:0xf
    v_mov_b32 v4, v6
    v_mov_b32 v5, v7
    s_cmp_eq_u32 s64, 8
    s_cbranch_scc1 k1_e5_chain2
    v_fma_f32 v6, v12, v4, v50
    v_fma_f32 v7, v13, v5, v130
    v_fmac_f32_dpp v6, v4, v14 quad_perm:[1,0,3,2] row_mask:0xf bank_mask:0xf
    v_fmac_f32_dpp v7, v5, v15 quad_perm:[1,0,3,2] row_mask:0xf bank_mask:0xf
    v_mov_b32 v4, v6
    v_mov_b32 v5, v7
    s_cmp_eq_u32 s64, 9
    s_cbranch_scc1 k1_e5_chain2
    v_fma_f32 v6, v12, v4, v52
    v_fma_f32 v7, v13, v5, v132
    v_fmac_f32_dpp v6, v4, v14 quad_perm:[1,0,3,2] row_mask:0xf bank_mask:0xf
    v_fmac_f32_dpp v7, v5, v15 quad_perm:[1,0,3,2] row_mask:0xf bank_mask:0xf
    v_mov_b32 v4, v6
    v_mov_b32 v5, v7
    s_cmp_eq_u32 s64, 10
    s_cbranch_scc1 k1_e5_chain2
    v_fma_f32 v6, v12, v4, v54
    v_fma_f32 v7, v13, v5, v134
    v_fmac_f32_dpp v6, v4, v14 quad_perm:[1,0,3,2] row_mask:0xf bank_mask:0xf
    v_fmac_f32_dpp v7, v5, v15 quad_perm:[1,0,3,2] row_mask:0xf bank_mask:0xf
    v_mov_b32 v4, v6
    v_mov_b32 v5, v7
    s_cmp_eq_u32 s64, 11
    s_cbranch_scc1 k1_e5_chain2
    v_fma_f32 v6, v12, v4, v56
    v_fma_f32 v7, v13, v5, v136
    v_fmac_f32_dpp v6, v4, v14 quad_perm:[1,0,3,2] row_mask:0xf bank_mask:0xf
    v_fmac_f32_dpp v7, v5, v15 quad_perm:[1,0,3,2] row_mask:0xf bank_mask:0xf
    v_mov_b32 v4, v6
    v_mov_b32 v5, v7
    s_cmp_eq_u32 s64, 12
    s_cbranch_scc1 k1_e5_chain2
    v_fma_f32 v6, v12, v4, v58
    v_fma_f32 v7, v13, v5, v138
    v_fmac_f32_dpp v6, v4, v14 quad_perm:[1,0,3,2] row_mask:0xf bank_mask:0xf
    v_fmac_f32_dpp v7, v5, v15 quad_perm:[1,0,3,2] row_mask:0xf bank_mask:0xf
    v_mov_b32 v4, v6
    v_mov_b32 v5, v7
    s_cmp_eq_u32 s64, 13
    s_cbranch_scc1 k1_e5_chain2
    v_fma_f32 v6, v12, v4, v60
    v_fma_f32 v7, v13, v5, v140
    v_fmac_f32_dpp v6, v4, v14 quad_perm:[1,0,3,2] row_mask:0xf bank_mask:0xf
    v_fmac_f32_dpp v7, v5, v15 quad_perm:[1,0,3,2] row_mask:0xf bank_mask:0xf
    v_mov_b32 v4, v6
    v_mov_b32 v5, v7
    s_cmp_eq_u32 s64, 14
    s_cbranch_scc1 k1_e5_chain2
    v_fma_f32 v6, v12, v4, v62
    v_fma_f32 v7, v13, v5, v142
    v_fmac_f32_dpp v6, v4, v14 quad_perm:[1,0,3,2] row_mask:0xf bank_mask:0xf
    v_fmac_f32_dpp v7, v5, v15 quad_perm:[1,0,3,2] row_mask:0xf bank_mask:0xf
    v_mov_b32 v4, v6
    v_mov_b32 v5, v7
k1_e5_chain2:
    s_nop 1
    ds_write_b32 v16, v4 offset:0
    s_mov_b64 exec, 0xffff
    ds_write_b32 v17, v5 offset:0
    s_mov_b64 exec, -1
    v_fma_f32 v6, v8, v4, v64
    v_fma_f32 v7, v9, v5, v80
    v_fmac_f32_dpp v6, v4, v10 quad_perm:[1,0,3,2] row_mask:0xf bank_mask:0xf
    v_fmac_f32_dpp v7, v5, v11 quad_perm:[1,0,3,2] row_mask:0xf bank_mask:0xf
    v_mov_b32 v4, v6
    v_mov_b32 v5, v7
    ds_write_b32 v16, v4 offset:320
    s_mov_b64 exec, 0xffff
    ds_write_b32 v17, v5 offset:320
    s_mov_b64 exec, -1
    v_fma_f32 v6, v8, v4, v65
    v_fma_f32 v7, v9, v5, v81
    v_fmac_f32_dpp v6, v4, v10 quad_perm:[1,0,3,2] row_mask:0xf bank_mask:0xf
    v_fmac_f32_dpp v7, v5, v11 quad_perm:[1,0,3,2] row_mask:0xf bank_mask:0xf
    v_mov_b32 v4, v6
    v_mov_b32 v5, v7
    ds_write_b32 v16, v4 offset:640
    s_mov_b64 exec, 0xffff
    ds_write_b32 v17, v5 offset:640
    s_mov_b64 exec, -1
    v_fma_f32 v6, v8, v4, v66
    v_fma_f32 v7, v9, v5, v82
    v_fmac_f32_dpp v6, v4, v10 quad_perm:[1,0,3,2] row_mask:0xf bank_mask:0xf
    v_fmac_f32_dpp v7, v5, v11 quad_perm:[1,0,3,2] row_mask:0xf bank_mask:0xf
    v_mov_b32 v4, v6
    v_mov_b32 v5, v7
    ds_write_b32 v16, v4 offset:960
    s_mov_b64 exec, 0xffff
    ds_write_b32 v17, v5 offset:960
    s_mov_b64 exec, -1
    v_fma_f32 v6, v8, v4, v67
    v_fma_f32 v7, v9, v5, v83
    v_fmac_f32_dpp v6, v4, v10 quad_perm:[1,0,3,2] row_mask:0xf bank_mask:0xf
    v_fmac_f32_dpp v7, v5, v11 quad_perm:[1,0,3,2] row_mask:0xf bank_mask:0xf
    v_mov_b32 v4, v6
    v_mov_b32 v5, v7
    ds_write_b32 v16, v4 offset:1280
    s_mov_b64 exec, 0xffff
    ds_write_b32 v17, v5 offset:1280
    s_mov_b64 exec, -1
    v_fma_f32 v6, v8, v4, v68
    v_fma_f32 v7, v9, v5, v84
    v_fmac_f32_dpp v6, v4, v10 quad_perm:[1,0,3,2] row_mask:0xf bank_mask:0xf
    v_fmac_f32_dpp v7, v5, v11 quad_perm:[1,0,3,2] row_mask:0xf bank_mask:0xf
    v_mov_b32 v4, v6
    v_mov_b32 v5, v7
    ds_write_b32 v16, v4 offset:1600
    s_mov_b64 exec, 0xffff
    ds_write_b32 v17, v5 offset:1600
    s_mov_b64 exec, -1
    v_fma_f32 v6, v8, v4, v69
    v_fma_f32 v7, v9, v5, v85
    v_fmac_f32_dpp v6, v4, v10 quad_perm:[1,0,3,2] row_mask:0xf bank_mask:0xf
    v_fmac_f32_dpp v7, v5, v11 quad_perm:[1,0,3,2] row_mask:0xf bank_mask:0xf
    v_mov_b32 v4, v6
    v_mov_b32 v5, v7
    ds_write_b32 v16, v4 offset:1920
    s_mov_b64 exec, 0xffff
    ds_write_b32 v17, v5 offset:1920
    s_mov_b64 exec, -1
    v_fma_f32 v6, v8, v4, v70
    v_fma_f32 v7, v9, v5, v86
    v_fmac_f32_dpp v6, v4, v10 quad_perm:[1,0,3,2] row_mask:0xf bank_mask:0xf
    v_fmac_f32_dpp v7, v5, v11 quad_perm:[1,0,3,2] row_mask:0xf bank_mask:0xf
    v_mov_b32 v4, v6
    v_mov_b32 v5, v7
    ds_write_b32 v16, v4 offset:2240
    s_mov_b64 exec, 0xffff
    ds_write_b32 v17, v5 offset:2240
    s_mov_b64 exec, -1
    v_fma_f32 v6, v8, v4, v71
    v_fma_f32 v7, v9, v5, v87
    v_fmac_f32_dpp v6, v4, v10 quad_perm:[1,0,3,2] row_mask:0xf bank_mask:0xf
    v_fmac_f32_dpp v7, v5, v11 quad_perm:[1,0,3,2] row_mask:0xf bank_mask:0xf
    v_mov_b32 v4, v6
    v_mov_b32 v5, v7
    ds_write_b32 v16, v4 offset:2560
    s_mov_b64 exec, 0xffff
    ds_write_b32 v17, v5 offset:2560
    s_mov_b64 exec, -1
    v_fma_f32 v6, v8, v4, v72
    v_fma_f32 v7, v9, v5, v88
    v_fmac_f32_dpp v6, v4, v10 quad_perm:[1,0,3,2] row_mask:0xf bank_mask:0xf
    v_fmac_f32_dpp v7, v5, v11 quad_perm:[1,0,3,2] row_mask:0xf bank_mask:0xf
    v_mov_b32 v4, v6
    v_mov_b32 v5, v7
    ds_write_b32 v16, v4 offset:2880
    s_mov_b64 exec, 0xffff
    ds_write_b32 v17, v5 offset:2880
    s_mov_b64 exec, -1
    v_fma_f32 v6, v8, v4, v73
    v_fma_f32 v7, v9, v5, v89
    v_fmac_f32_dpp v6, v4, v10 quad_perm:[1,0,3,2] row_mask:0xf bank_mask:0xf
    v_fmac_f32_dpp v7, v5, v11 quad_perm:[1,0,3,2] row_mask:0xf bank_mask:0xf
    v_mov_b32 v4, v6
    v_mov_b32 v5, v7
    ds_write_b32 v16, v4 offset:3200
    s_mov_b64 exec, 0xffff
    ds_write_b32 v17, v5 offset:3200
    s_mov_b64 exec, -1
    v_fma_f32 v6, v8, v4, v74
    v_fma_f32 v7, v9, v5, v90
    v_fmac_f32_dpp v6, v4, v10 quad_perm:[1,0,3,2] row_mask:0xf bank_mask:0xf
    v_fmac_f32_dpp v7, v5, v11 quad_perm:[1,0,3,2] row_mask:0xf bank_mask:0xf
    v_mov_b32 v4, v6
    v_mov_b32 v5, v7
    ds_write_b32 v16, v4 offset:3520
    s_mov_b64 exec, 0xffff
    ds_write_b32 v17, v5 offset:3520
    s_mov_b64 exec, -1
    v_fma_f32 v6, v8, v4, v75
    v_fma_f32 v7, v9, v5, v91
    v_fmac_f32_dpp v6, v4, v10 quad_perm:[1,0,3,2] row_mask:0xf bank_mask:0xf
    v_fmac_f32_dpp v7, v5, v11 quad_perm:[1,0,3,2] row_mask:0xf bank_mask:0xf
    v_mov_b32 v4, v6
    v_mov_b32 v5, v7
    ds_write_b32 v16, v4 offset:3840
    s_mov_b64 exec, 0xffff
    ds_write_b32 v17, v5 offset:3840
    s_mov_b64 exec, -1
    v_fma_f32 v6, v8, v4, v76
    v_fma_f32 v7, v9, v5, v92
    v_fmac_f32_dpp v6, v4, v10 quad_perm:[1,0,3,2] row_mask:0xf bank_mask:0xf
    v_fmac_f32_dpp v7, v5, v11 quad_perm:[1,0,3,2] row_mask:0xf bank_mask:0xf
    v_mov_b32 v4, v6
    v_mov_b32 v5, v7
    ds_write_b32 v16, v4 offset:4160
    s_mov_b64 exec, 0xffff
    ds_write_b32 v17, v5 offset:4160
    s_mov_b64 exec, -1
    v_fma_f32 v6, v8, v4, v77
    v_fma_f32 v7, v9, v5, v93
    v_fmac_f32_dpp v6, v4, v10 quad_perm:[1,0,3,2] row_mask:0xf bank_mask:0xf
    v_fmac_f32_dpp v7, v5, v11 quad_perm:[1,0,3,2] row_mask:0xf bank_mask:0xf
    v_mov_b32 v4, v6
    v_mov_b32 v5, v7
    ds_write_b32 v16, v4 offset:4480
    s_mov_b64 exec, 0xffff
    ds_write_b32 v17, v5 offset:4480
    s_mov_b64 exec, -1
    v_fma_f32 v6, v8, v4, v78
    v_fma_f32 v7, v9, v5, v94
    v_fmac_f32_dpp v6, v4, v10 quad_perm:[1,0,3,2] row_mask:0xf bank_mask:0xf
    v_fmac_f32_dpp v7, v5, v11 quad_perm:[1,0,3,2] row_mask:0xf bank_mask:0xf
    v_mov_b32 v4, v6
    v_mov_b32 v5, v7
    ds_write_b32 v16, v4 offset:4800
    s_mov_b64 exec, 0xffff
    ds_write_b32 v17, v5 offset:4800
    s_mov_b64 exec, -1
    s_waitcnt lgkmcnt(0)
    v_mov_b32 v24, 157952
    v_mov_b32 v25, 1
    ds_write_b32 v24, v25
    s_setprio 3
k2_lsetup:
    s_mov_b32 s44, s38
    s_and_b32 s45, s39, 0xffff
    s_mov_b32 s46, 268435456
    s_mov_b32 s47, 0x00020000
    v_mov_b32 v28, 157952
k2_bspin:
    ds_read_b32 v29, v28 offset:4
    s_waitcnt lgkmcnt(0)
    v_readfirstlane_b32 s76, v29
    s_nop 3
    s_cmp_eq_u32 s76, 4
    s_cbranch_scc1 k2_bgo
    s_sleep 4
    s_branch k2_bspin
k2_bgo:
    v_min_u32 v25, 47, v1
    v_lshrrev_b32 v27, 1, v25
    v_and_b32 v25, 1, v25
    s_mul_i32 s76, s13, 80
    s_lshr_b32 s77, s76, 6
    s_add_u32 s76, s76, 79
    s_lshr_b32 s76, s76, 6
    s_sub_u32 s76, s76, s77
    v_mul_u32_u24 v25, s76, v25
    v_add_u32 v25, s77, v25
    v_mul_u32_u24 v27, 10, v27
    v_add_u32 v25, v25, v27
    v_lshlrev_b32 v25, 7, v25
    v_add_u32 v25, 0xb50000, v25
    s_mov_b32 s81, 0
k2_poll_w2:
    buffer_load_dword v26, v25, s[52:55], 0 offen sc1
    s_waitcnt vmcnt(0)
    v_cmp_eq_u32 vcc, 1, v26
    s_cmp_eq_u64 vcc, -1
    s_cbranch_scc1 k2_polld_w2
    s_sleep 6
    s_add_u32 s81, s81, 1
    s_cmp_lt_u32 s81, 0x40000
    s_cbranch_scc1 k2_poll_w2
k2_polld_w2:
    s_add_u32 s79, s14, 0
    s_lshl_b32 s71, s79, 8
    s_add_u32 m0, s61, 0
    s_nop 0
    buffer_load_dwordx4 v144, s[44:47], s71 offen sc1 lds
    s_add_u32 m0, s61, 1024
    s_nop 0
    buffer_load_dwordx4 v145, s[44:47], s71 offen sc1 lds
    s_add_u32 m0, s61, 2048
    s_nop 0
    buffer_load_dwordx4 v146, s[44:47], s71 offen sc1 lds
    s_add_u32 m0, s61, 3072
    s_nop 0
    buffer_load_dwordx4 v147, s[44:47], s71 offen sc1 lds
    s_add_u32 m0, s61, 4096
    s_nop 0
    buffer_load_dwordx4 v148, s[44:47], s71 offen sc1 lds
    s_mov_b32 s81, 0
k2_poll_act:
    buffer_load_dword v26, v149, s[52:55], 0 offen sc1
    s_waitcnt vmcnt(0)
    v_cmp_eq_u32 vcc, 1, v26
    s_cmp_eq_u64 vcc, -1
    s_cbranch_scc1 k2_polld_act
    s_sleep 6
    s_add_u32 s81, s81, 1
    s_cmp_lt_u32 s81, 0x40000
    s_cbranch_scc1 k2_poll_act
k2_polld_act:
    s_add_u32 s77, s14, 10
    s_lshl_b32 s70, s77, 14
    s_add_u32 m0, s60, 0
    s_nop 0
    buffer_load_dwordx4 v104, s[52:55], s70 offen sc1 lds
    s_add_u32 m0, s60, 1024
    s_nop 0
    buffer_load_dwordx4 v105, s[52:55], s70 offen sc1 lds
    s_add_u32 m0, s60, 2048
    s_nop 0
    buffer_load_dwordx4 v106, s[52:55], s70 offen sc1 lds
    s_add_u32 m0, s60, 3072
    s_nop 0
    buffer_load_dwordx4 v107, s[52:55], s70 offen sc1 lds
    s_add_u32 s79, s14, 1
    s_lshl_b32 s71, s79, 8
    s_add_u32 m0, s61, 36864
    s_nop 0
    buffer_load_dwordx4 v144, s[44:47], s71 offen sc1 lds
    s_add_u32 m0, s61, 37888
    s_nop 0
    buffer_load_dwordx4 v145, s[44:47], s71 offen sc1 lds
    s_add_u32 m0, s61, 38912
    s_nop 0
    buffer_load_dwordx4 v146, s[44:47], s71 offen sc1 lds
    s_add_u32 m0, s61, 39936
    s_nop 0
    buffer_load_dwordx4 v147, s[44:47], s71 offen sc1 lds
    s_add_u32 m0, s61, 40960
    s_nop 0
    buffer_load_dwordx4 v148, s[44:47], s71 offen sc1 lds
    s_add_u32 s77, s14, 11
    s_lshl_b32 s70, s77, 14
    s_add_u32 m0, s60, 36864
    s_nop 0
    buffer_load_dwordx4 v104, s[52:55], s70 offen sc1 lds
    s_add_u32 m0, s60, 37888
    s_nop 0
    buffer_load_dwordx4 v105, s[52:55], s70 offen sc1 lds
    s_add_u32 m0, s60, 38912
    s_nop 0
    buffer_load_dwordx4 v106, s[52:55], s70 offen sc1 lds
    s_add_u32 m0, s60, 39936
    s_nop 0
    buffer_load_dwordx4 v107, s[52:55], s70 offen sc1 lds
    s_waitcnt vmcnt(9)
    s_barrier
    s_add_u32 s79, s14, 2
    s_lshl_b32 s71, s79, 8
    s_add_u32 m0, s61, 73728
    s_nop 0
    buffer_load_dwordx4 v144, s[44:47], s71 offen sc1 lds
    s_add_u32 m0, s61, 74752
    s_nop 0
    buffer_load_dwordx4 v145, s[44:47], s71 offen sc1 lds
    s_add_u32 m0, s61, 75776
    s_nop 0
    buffer_load_dwordx4 v146, s[44:47], s71 offen sc1 lds
    s_add_u32 m0, s61, 76800
    s_nop 0
    buffer_load_dwordx4 v147, s[44:47], s71 offen sc1 lds
    s_add_u32 m0, s61, 77824
    s_nop 0
    buffer_load_dwordx4 v148, s[44:47], s71 offen sc1 lds
    s_add_u32 s77, s14, 12
    s_lshl_b32 s70, s77, 14
    s_add_u32 m0, s60, 73728
    s_nop 0
    buffer_load_dwordx4 v104, s[52:55], s70 offen sc1 lds
    s_add_u32 m0, s60, 74752
    s_nop 0
    buffer_load_dwordx4 v105, s[52:55], s70 offen sc1 lds
    s_add_u32 m0, s60, 75776
    s_nop 0
    buffer_load_dwordx4 v106, s[52:55], s70 offen sc1 lds
    s_add_u32 m0, s60, 76800
    s_nop 0
    buffer_load_dwordx4 v107, s[52:55], s70 offen sc1 lds
    s_add_u32 s79, s14, 3
    s_lshl_b32 s71, s79, 8
    s_add_u32 m0, s61, 110592
    s_nop 0
    buffer_load_dwordx4 v144, s[44:47], s71 offen sc1 lds
    s_add_u32 m0, s61, 111616
    s_nop 0
    buffer_load_dwordx4 v145, s[44:47], s71 offen sc1 lds
    s_add_u32 m0, s61, 112640
    s_nop 0
    buffer_load_dwordx4 v146, s[44:47], s71 offen sc1 lds
    s_add_u32 m0, s61, 113664
    s_nop 0
    buffer_load_dwordx4 v147, s[44:47], s71 offen sc1 lds
    s_add_u32 m0, s61, 114688
    s_nop 0
    buffer_load_dwordx4 v148, s[44:47], s71 offen sc1 lds
    s_add_u32 s77, s14, 13
    s_lshl_b32 s70, s77, 14
    s_add_u32 m0, s60, 110592
    s_nop 0
    buffer_load_dwordx4 v104, s[52:55], s70 offen sc1 lds
    s_add_u32 m0, s60, 111616
    s_nop 0
    buffer_load_dwordx4 v105, s[52:55], s70 offen sc1 lds
    s_add_u32 m0, s60, 112640
    s_nop 0
    buffer_load_dwordx4 v106, s[52:55], s70 offen sc1 lds
    s_add_u32 m0, s60, 113664
    s_nop 0
    buffer_load_dwordx4 v107, s[52:55], s70 offen sc1 lds
    s_add_u32 s14, s14, 4
    s_mov_b32 s80, 4
    s_mov_b32 s73, 0
    s_mov_b32 s72, 0
k2_lloop:
    s_waitcnt vmcnt(18)
    s_barrier
    s_cmp_ge_u32 s80, 12
    s_cselect_b32 s76, 10, 12
    s_cmp_ge_u32 s14, s76
    s_cselect_b32 s14, 0, s14
    s_cmp_eq_u32 s80, 12
    s_cbranch_scc0 k2_sw_0
    s_mov_b32 s81, 0
k2_poll_h0:
    buffer_load_dword v26, v150, s[52:55], 0 offen sc1
    s_waitcnt vmcnt(0)
    v_cmp_eq_u32 vcc, 1, v26
    s_cmp_eq_u64 vcc, -1
    s_cbranch_scc1 k2_polld_h0
    s_sleep 6
    s_add_u32 s81, s81, 1
    s_cmp_lt_u32 s81, 0x40000
    s_cbranch_scc1 k2_poll_h0
k2_polld_h0:
    s_mov_b32 s46, 819200
    s_mov_b32 s14, s15
    v_mov_b32 v144, v108
    v_mov_b32 v145, v109
    v_mov_b32 v146, v110
    v_mov_b32 v147, v111
    v_mov_b32 v148, v112
k2_sw_0:
    s_cmp_ge_u32 s80, 12
    s_cbranch_scc0 k2_phb_0
    s_cmp_ge_u32 s14, 5
    s_cselect_b32 s44, s6, s4
    s_cselect_b32 s76, s7, s5
    s_cselect_b32 s77, 5, 0
    s_and_b32 s45, s76, 0xffff
    s_sub_u32 s77, s14, s77
    s_lshl_b32 s71, s77, 8
    s_lshl_b32 s70, s14, 14
    s_branch k2_go_0
k2_phb_0:
    s_lshl_b32 s71, s14, 8
    s_add_u32 s77, s14, 10
    s_lshl_b32 s70, s77, 14
k2_go_0:
    s_add_u32 s76, s61, s73
    s_add_u32 m0, s76, 0
    s_nop 0
    buffer_load_dwordx4 v144, s[44:47], s71 offen sc1 lds
    s_add_u32 s76, s61, s73
    s_add_u32 m0, s76, 1024
    s_nop 0
    buffer_load_dwordx4 v145, s[44:47], s71 offen sc1 lds
    s_add_u32 s76, s61, s73
    s_add_u32 m0, s76, 2048
    s_nop 0
    buffer_load_dwordx4 v146, s[44:47], s71 offen sc1 lds
    s_add_u32 s76, s61, s73
    s_add_u32 m0, s76, 3072
    s_nop 0
    buffer_load_dwordx4 v147, s[44:47], s71 offen sc1 lds
    s_add_u32 s76, s61, s73
    s_add_u32 m0, s76, 4096
    s_nop 0
    buffer_load_dwordx4 v148, s[44:47], s71 offen sc1 lds
    s_add_u32 s76, s60, s73
    s_add_u32 m0, s76, 0
    s_nop 0
    buffer_load_dwordx4 v104, s[52:55], s70 offen sc1 lds
    s_add_u32 s76, s60, s73
    s_add_u32 m0, s76, 1024
    s_nop 0
    buffer_load_dwordx4 v105, s[52:55], s70 offen sc1 lds
    s_add_u32 s76, s60, s73
    s_add_u32 m0, s76, 2048
    s_nop 0
    buffer_load_dwordx4 v106, s[52:55], s70 offen sc1 lds
    s_add_u32 s76, s60, s73
    s_add_u32 m0, s76, 3072
    s_nop 0
    buffer_load_dwordx4 v107, s[52:55], s70 offen sc1 lds
    s_add_u32 s73, s73, 36864
    s_cmp_ge_u32 s73, 147456
    s_cselect_b32 s73, 0, s73
    s_add_u32 s80, s80, 1
    s_add_u32 s14, s14, 1
    s_add_u32 s72, s72, 1
    s_cmp_lt_u32 s72, 18
    s_cbranch_scc1 k2_lloop
    s_waitcnt vmcnt(18)
    s_barrier
    s_waitcnt vmcnt(9)
    s_barrier
    s_waitcnt vmcnt(0)
    s_barrier
    s_endpgm
k_compute:
    v_and_b32 v24, 15, v1
    v_lshrrev_b32 v25, 4, v1
    v_lshrrev_b32 v26, 2, v24
    v_and_b32 v27, 3, v24
    v_lshl_add_u32 v27, v26, 3, v27
    s_lshl_b32 s76, s66, 5
    v_add_u32 v27, s76, v27
    v_lshlrev_b32 v27, 7, v27
    v_bfe_u32 v28, v24, 1, 1
    v_lshl_add_u32 v28, v26, 1, v28
    v_xor_b32 v28, v28, v25
    v_lshl_add_u32 v12, v28, 4, v27
    v_xor_b32 v13, 64, v12
    v_and_b32 v26, 1, v24
    v_lshrrev_b32 v27, 1, v24
    v_mul_u32_u24 v28, 40, v26
    v_add_u32 v28, v28, v27
    v_lshlrev_b32 v28, 7, v28
    v_and_b32 v27, 6, v27
    v_or_b32 v27, v27, v26
    v_xor_b32 v27, v27, v25
    v_lshl_add_u32 v28, v27, 4, v28
    v_add_u32 v14, 16384, v28
    v_xor_b32 v15, 64, v14
    v_lshrrev_b32 v26, 2, v24
    v_lshl_add_u32 v26, v25, 3, v26
    v_mul_u32_u24 v26, 192, v26
    v_and_b32 v27, 3, v24
    v_lshl_add_u32 v26, v27, 3, v26
    v_add_u32 v26, 26624, v26
    v_and_b32 v27, 1, v25
    v_lshl_add_u32 v16, v27, 5, v26
    v_mul_u32_u24 v27, 160, v27
    v_sub_u32 v27, 160, v27
    v_add_u32 v17, v26, v27
    s_mov_b32 s74, 0
    v_mov_b32 v64, 0
    v_mov_b32 v65, 0
    v_mov_b32 v66, 0
    v_mov_b32 v67, 0
    v_mov_b32 v68, 0
    v_mov_b32 v69, 0
    v_mov_b32 v70, 0
    v_mov_b32 v71, 0
    v_mov_b32 v72, 0
    v_mov_b32 v73, 0
    v_mov_b32 v74, 0
    v_mov_b32 v75, 0
    v_mov_b32 v76, 0
    v_mov_b32 v77, 0
    v_mov_b32 v78, 0
    v_mov_b32 v79, 0
    v_mov_b32 v80, 0
    v_mov_b32 v81, 0
    v_mov_b32 v82, 0
    v_mov_b32 v83, 0
    v_mov_b32 v84, 0
    v_mov_b32 v85, 0
    v_mov_b32 v86, 0
    v_mov_b32 v87, 0
    v_mov_b32 v88, 0
    v_mov_b32 v89, 0
    v_mov_b32 v90, 0
    v_mov_b32 v91, 0
    v_mov_b32 v92, 0
    v_mov_b32 v93, 0
    v_mov_b32 v94, 0
    v_mov_b32 v95, 0
    v_mov_b32 v96, 0
    v_mov_b32 v97, 0
    v_mov_b32 v98, 0
    v_mov_b32 v99, 0
    v_mov_b32 v100, 0
    v_mov_b32 v101, 0
    v_mov_b32 v102, 0
    v_mov_b32 v103, 0
    v_mov_b32 v104, 0
    v_mov_b32 v105, 0
    v_mov_b32 v106, 0
    v_mov_b32 v107, 0
    v_mov_b32 v108, 0
    v_mov_b32 v109, 0
    v_mov_b32 v110, 0
    v_mov_b32 v111, 0
    v_mov_b32 v112, 0
    v_mov_b32 v113, 0
    v_mov_b32 v114, 0
    v_mov_b32 v115, 0
    v_mov_b32 v116, 0
    v_mov_b32 v117, 0
    v_mov_b32 v118, 0
    v_mov_b32 v119, 0
    v_mov_b32 v120, 0
    v_mov_b32 v121, 0
    v_mov_b32 v122, 0
    v_mov_b32 v123, 0
    v_mov_b32 v124, 0
    v_mov_b32 v125, 0
    v_mov_b32 v126, 0
    v_mov_b32 v127, 0
    v_mov_b32 v128, 0
    v_mov_b32 v129, 0
    v_mov_b32 v130, 0
    v_mov_b32 v131, 0
    v_mov_b32 v132, 0
    v_mov_b32 v133, 0
    v_mov_b32 v134, 0
    v_mov_b32 v135, 0
    v_mov_b32 v136, 0
    v_mov_b32 v137, 0
    v_mov_b32 v138, 0
    v_mov_b32 v139, 0
    v_mov_b32 v140, 0
    v_mov_b32 v141, 0
    v_mov_b32 v142, 0
    v_mov_b32 v143, 0
    v_mov_b32 v144, 0
    v_mov_b32 v145, 0
    v_mov_b32 v146, 0
    v_mov_b32 v147, 0
    v_mov_b32 v148, 0
    v_mov_b32 v149, 0
    v_mov_b32 v150, 0
    v_mov_b32 v151, 0
    s_waitcnt lgkmcnt(0)
    s_mov_b32 s52, s38
    s_and_b32 s53, s39, 0xffff
    s_mov_b32 s54, 268435456
    s_mov_b32 s55, 0x00020000
    s_mov_b32 s56, s36
    s_and_b32 s57, s37, 0xffff
    s_mov_b32 s58, 256
    s_mov_b32 s59, 0x00020000
    s_mov_b32 s60, s32
    s_and_b32 s61, s33, 0xffff
    s_mov_b32 s62, 1966080
    s_mov_b32 s63, 0x00020000
    s_mul_i32 s76, s65, 96
    v_and_b32 v24, 15, v1
    v_add_u32 v24, s76, v24
    v_lshlrev_b32 v24, 1, v24
    global_load_ushort v18, v24, s[30:31] offset:0
    global_load_ushort v19, v24, s[30:31] offset:32
    global_load_ushort v20, v24, s[30:31] offset:64
    global_load_ushort v21, v24, s[30:31] offset:96
    global_load_ushort v22, v24, s[30:31] offset:128
    global_load_ushort v23, v24, s[30:31] offset:160
    s_cmp_eq_u32 s66, 1
    s_cbranch_scc0 k1_noclr
    s_lshl_b32 s77, s64, 4
    s_add_u32 s77, s77, s65
    s_mul_i32 s76, s77, 640
    s_add_u32 s76, s76, 0xb02000
    v_lshlrev_b32 v26, 3, v1
    v_mov_b32 v30, 0
    v_mov_b32 v31, 0
    buffer_store_dwordx2 v[30:31], v26, s[52:55], s76 offen sc1
    s_mov_b64 exec, 0xffff
    buffer_store_dwordx2 v[30:31], v26, s[52:55], s76 offen offset:512 sc1
    s_mov_b64 exec, 15
    s_lshl_b32 s76, s77, 7
    s_add_u32 s76, s76, 0xb40000
    buffer_store_dwordx2 v[30:31], v26, s[52:55], s76 offen sc1
    s_mov_b64 exec, 1
    s_lshl_b32 s76, s2, 7
    s_add_u32 s76, s76, 0xb50000
    buffer_store_dword v30, v26, s[52:55], s76 offen sc1
    s_mov_b64 exec, -1
k1_noclr:
    s_cmp_eq_u32 s66, 3
    s_cbranch_scc0 k1_now2a
    s_cmp_ge_u32 s2, 240
    s_cbranch_scc1 k1_now2a
    s_mul_i32 s76, s2, 0x199a
    s_lshr_b32 s76, s76, 16
    s_mul_i32 s77, s76, 10
    s_sub_u32 s77, s2, s77
    s_lshl_b32 s76, s76, 6
    s_mul_i32 s76, s76, 1280
    s_lshl_b32 s77, s77, 7
    s_add_u32 s76, s76, s77
    v_lshrrev_b32 v24, 3, v1
    v_mul_u32_u24 v24, 1280, v24
    v_and_b32 v25, 7, v1
    v_lshl_add_u32 v24, v25, 4, v24
    s_mov_b32 m0, 118784
    s_nop 0
    buffer_load_dwordx4 v24, s[60:63], s76 offen lds
    s_add_u32 s76, s76, 10240
    s_mov_b32 m0, 119808
    s_nop 0
    buffer_load_dwordx4 v24, s[60:63], s76 offen lds
    s_add_u32 s76, s76, 10240
    s_mov_b32 m0, 120832
    s_nop 0
    buffer_load_dwordx4 v24, s[60:63], s76 offen lds
    s_add_u32 s76, s76, 10240
    s_mov_b32 m0, 121856
    s_nop 0
    buffer_load_dwordx4 v24, s[60:63], s76 offen lds
    s_add_u32 s76, s76, 10240
    s_mov_b32 m0, 122880
    s_nop 0
    buffer_load_dwordx4 v24, s[60:63], s76 offen lds
    s_add_u32 s76, s76, 10240
    s_mov_b32 m0, 123904
    s_nop 0
    buffer_load_dwordx4 v24, s[60:63], s76 offen lds
    s_add_u32 s76, s76, 10240
    s_mov_b32 m0, 124928
    s_nop 0
    buffer_load_dwordx4 v24, s[60:63], s76 offen lds
    s_add_u32 s76, s76, 10240
    s_mov_b32 m0, 125952
    s_nop 0
    buffer_load_dwordx4 v24, s[60:63], s76 offen lds
k1_now2a:
    s_barrier
    ds_read_b128 a[0:3], v12 offset:0
    ds_read_b128 a[4:7], v12 offset:512
    ds_read_b128 a[8:11], v14 offset:0
    ds_read_b128 a[12:15], v14 offset:1024
    ds_read_b128 a[16:19], v14 offset:2048
    ds_read_b128 a[20:23], v14 offset:3072
    ds_read_b128 a[24:27], v14 offset:4096
    ds_read_b64_tr_b16 a[28:29], v16 offset:0
    ds_read_b64_tr_b16 a[30:31], v16 offset:768
    ds_read_b64_tr_b16 a[32:33], v16 offset:32
    ds_read_b64_tr_b16 a[34:35], v16 offset:800
    ds_read_b64_tr_b16 a[36:37], v16 offset:64
    ds_read_b64_tr_b16 a[38:39], v16 offset:832
    ds_read_b64_tr_b16 a[40:41], v16 offset:96
    ds_read_b64_tr_b16 a[42:43], v16 offset:864
    ds_read_b64_tr_b16 a[44:45], v16 offset:128
    ds_read_b64_tr_b16 a[46:47], v16 offset:896
    ds_read_b64_tr_b16 a[48:49], v17 offset:0
    ds_read_b64_tr_b16 a[50:51], v17 offset:768
    s_mov_b32 s72, 0
k1_loop:
    s_waitcnt lgkmcnt(0)
    v_mfma_f32_16x16x32_bf16 v[64:67], a[0:3], a[8:11], v[64:67]
    ds_read_b128 a[52:55], v13 offset:0
    v_mfma_f32_16x16x32_bf16 v[68:71], a[4:7], a[8:11], v[68:71]
    ds_read_b128 a[56:59], v13 offset:512
    v_mfma_f32_16x16x32_bf16 v[72:75], a[0:3], a[12:15], v[72:75]
    ds_read_b128 a[60:63], v15 offset:0
    v_mfma_f32_16x16x32_bf16 v[76:79], a[4:7], a[12:15], v[76:79]
    ds_read_b128 a[64:67], v15 offset:1024
    v_mfma_f32_16x16x32_bf16 v[80:83], a[0:3], a[16:19], v[80:83]
    ds_read_b128 a[68:71], v15 offset:2048
    v_mfma_f32_16x16x32_bf16 v[84:87], a[4:7], a[16:19], v[84:87]
    ds_read_b128 a[72:75], v15 offset:3072
    v_mfma_f32_16x16x32_bf16 v[88:91], a[0:3], a[20:23], v[88:91]
    ds_read_b128 a[76:79], v15 offset:4096
    v_mfma_f32_16x16x32_bf16 v[92:95], a[4:7], a[20:23], v[92:95]
    v_mfma_f32_16x16x32_bf16 v[96:99], a[0:3], a[24:27], v[96:99]
    ds_read_b64_tr_b16 a[80:81], v16 offset:6144
    v_mfma_f32_16x16x32_bf16 v[100:103], a[4:7], a[24:27], v[100:103]
    ds_read_b64_tr_b16 a[82:83], v16 offset:6912
    v_mfma_f32_16x16x32_bf16 v[104:107], a[0:3], a[28:31], v[104:107]
    ds_read_b64_tr_b16 a[84:85], v16 offset:6176
    v_mfma_f32_16x16x32_bf16 v[108:111], a[4:7], a[28:31], v[108:111]
    ds_read_b64_tr_b16 a[86:87], v16 offset:6944
    v_mfma_f32_16x16x32_bf16 v[112:115], a[0:3], a[32:35], v[112:115]
    ds_read_b64_tr_b16 a[88:89], v16 offset:6208
    v_mfma_f32_16x16x32_bf16 v[116:119], a[4:7], a[32:35], v[116:119]
    ds_read_b64_tr_b16 a[90:91], v16 offset:6976
    v_mfma_f32_16x16x32_bf16 v[120:123], a[0:3], a[36:39], v[120:123]
    v_mfma_f32_16x16x32_bf16 v[124:127], a[4:7], a[36:39], v[124:127]
    ds_read_b64_tr_b16 a[92:93], v16 offset:6240
    v_mfma_f32_16x16x32_bf16 v[128:131], a[0:3], a[40:43], v[128:131]
    ds_read_b64_tr_b16 a[94:95], v16 offset:7008
    v_mfma_f32_16x16x32_bf16 v[132:135], a[4:7], a[40:43], v[132:135]
    ds_read_b64_tr_b16 a[96:97], v16 offset:6272
    v_mfma_f32_16x16x32_bf16 v[136:139], a[0:3], a[44:47], v[136:139]
    ds_read_b64_tr_b16 a[98:99], v16 offset:7040
    v_mfma_f32_16x16x32_bf16 v[140:143], a[4:7], a[44:47], v[140:143]
    ds_read_b64_tr_b16 a[100:101], v17 offset:6144
    v_mfma_f32_16x16x32_bf16 v[144:147], a[0:3], a[48:51], v[144:147]
    ds_read_b64_tr_b16 a[102:103], v17 offset:6912
    v_mfma_f32_16x16x32_bf16 v[148:151], a[4:7], a[48:51], v[148:151]
    s_waitcnt lgkmcnt(0)
    s_barrier
    v_mfma_f32_16x16x32_bf16 v[64:67], a[52:55], a[60:63], v[64:67]
    s_add_u32 s77, s74, 38912
    s_cmp_ge_u32 s77, 116736
    s_cselect_b32 s77, 0, s77
    s_sub_u32 s78, s77, s74
    s_mov_b32 s74, s77
    v_add_u32 v12, s78, v12
    v_mfma_f32_16x16x32_bf16 v[68:71], a[56:59], a[60:63], v[68:71]
    v_add_u32 v13, s78, v13
    v_mfma_f32_16x16x32_bf16 v[72:75], a[52:55], a[64:67], v[72:75]
    v_add_u32 v14, s78, v14
    v_mfma_f32_16x16x32_bf16 v[76:79], a[56:59], a[64:67], v[76:79]
    v_add_u32 v15, s78, v15
    v_mfma_f32_16x16x32_bf16 v[80:83], a[52:55], a[68:71], v[80:83]
    v_add_u32 v16, s78, v16
    v_mfma_f32_16x16x32_bf16 v[84:87], a[56:59], a[68:71], v[84:87]
    v_add_u32 v17, s78, v17
    ds_read_b128 a[0:3], v12 offset:0
    v_mfma_f32_16x16x32_bf16 v[88:91], a[52:55], a[72:75], v[88:91]
    ds_read_b128 a[4:7], v12 offset:512
    v_mfma_f32_16x16x32_bf16 v[92:95], a[56:59], a[72:75], v[92:95]
    ds_read_b128 a[8:11], v14 offset:0
    v_mfma_f32_16x16x32_bf16 v[96:99], a[52:55], a[76:79], v[96:99]
    ds_read_b128 a[12:15], v14 offset:1024
    v_mfma_f32_16x16x32_bf16 v[100:103], a[56:59], a[76:79], v[100:103]
    ds_read_b128 a[16:19], v14 offset:2048
    v_mfma_f32_16x16x32_bf16 v[104:107], a[52:55], a[80:83], v[104:107]
    ds_read_b128 a[20:23], v14 offset:3072
    v_mfma_f32_16x16x32_bf16 v[108:111], a[56:59], a[80:83], v[108:111]
    ds_read_b128 a[24:27], v14 offset:4096
    ds_read_b64_tr_b16 a[28:29], v16 offset:0
    v_mfma_f32_16x16x32_bf16 v[112:115], a[52:55], a[84:87], v[112:115]
    ds_read_b64_tr_b16 a[30:31], v16 offset:768
    v_mfma_f32_16x16x32_bf16 v[116:119], a[56:59], a[84:87], v[116:119]
    ds_read_b64_tr_b16 a[32:33], v16 offset:32
    v_mfma_f32_16x16x32_bf16 v[120:123], a[52:55], a[88:91], v[120:123]
    ds_read_b64_tr_b16 a[34:35], v16 offset:800
    v_mfma_f32_16x16x32_bf16 v[124:127], a[56:59], a[88:91], v[124:127]
    ds_read_b64_tr_b16 a[36:37], v16 offset:64
    v_mfma_f32_16x16x32_bf16 v[128:131], a[52:55], a[92:95], v[128:131]
    ds_read_b64_tr_b16 a[38:39], v16 offset:832
    ds_read_b64_tr_b16 a[40:41], v16 offset:96
    v_mfma_f32_16x16x32_bf16 v[132:135], a[56:59], a[92:95], v[132:135]
    ds_read_b64_tr_b16 a[42:43], v16 offset:864
    v_mfma_f32_16x16x32_bf16 v[136:139], a[52:55], a[96:99], v[136:139]
    ds_read_b64_tr_b16 a[44:45], v16 offset:128
    v_mfma_f32_16x16x32_bf16 v[140:143], a[56:59], a[96:99], v[140:143]
    ds_read_b64_tr_b16 a[46:47], v16 offset:896
    v_mfma_f32_16x16x32_bf16 v[144:147], a[52:55], a[100:103], v[144:147]
    ds_read_b64_tr_b16 a[48:49], v17 offset:0
    v_mfma_f32_16x16x32_bf16 v[148:151], a[56:59], a[100:103], v[148:151]
    ds_read_b64_tr_b16 a[50:51], v17 offset:768
    s_add_u32 s72, s72, 1
    s_lshl_b32 s76, s72, 2
    s_add_u32 s76, s76, s66
    s_cmp_eq_u32 s76, 9
    s_cbranch_scc0 k1_noclr2
    s_waitcnt vmcnt(0)
    s_lshl_b32 s76, s65, 4
    s_add_u32 s76, s76, s64
    v_mov_b32 v30, 1
    v_mov_b32 v31, s76
    s_mov_b64 exec, 1
    buffer_store_byte v30, v31, s[56:59], 0 offen sc1
    s_mov_b64 exec, -1
    s_mov_b32 s76, 0
k1_noclr2:
    s_cmp_eq_u32 s76, 15
    s_cbranch_scc0 k1_now2b
    s_cmp_ge_u32 s2, 240
    s_cbranch_scc1 k1_now2b
    s_waitcnt vmcnt(0)
    v_and_b32 v24, 15, v1
    v_lshrrev_b32 v25, 4, v1
    v_lshrrev_b32 v26, 2, v24
    v_lshl_add_u32 v26, v25, 3, v26
    v_lshlrev_b32 v26, 7, v26
    v_and_b32 v27, 3, v24
    v_lshl_add_u32 v26, v27, 3, v26
    v_add_u32 v26, 118784, v26
    ds_read_b64_tr_b16 v[30:31], v26 offset:0
    ds_read_b64_tr_b16 v[32:33], v26 offset:512
    ds_read_b64_tr_b16 v[34:35], v26 offset:4096
    ds_read_b64_tr_b16 v[36:37], v26 offset:4608
    ds_read_b64_tr_b16 v[38:39], v26 offset:32
    ds_read_b64_tr_b16 v[40:41], v26 offset:544
    ds_read_b64_tr_b16 v[42:43], v26 offset:4128
    ds_read_b64_tr_b16 v[44:45], v26 offset:4640
    ds_read_b64_tr_b16 v[46:47], v26 offset:64
    ds_read_b64_tr_b16 v[48:49], v26 offset:576
    ds_read_b64_tr_b16 v[50:51], v26 offset:4160
    ds_read_b64_tr_b16 v[52:53], v26 offset:4672
    ds_read_b64_tr_b16 v[54:55], v26 offset:96
    ds_read_b64_tr_b16 v[56:57], v26 offset:608
    ds_read_b64_tr_b16 v[58:59], v26 offset:4192
    ds_read_b64_tr_b16 v[60:61], v26 offset:4704
    s_mul_i32 s76, s2, 0x199a
    s_lshr_b32 s76, s76, 16
    s_mul_i32 s77, s76, 10
    s_sub_u32 s77, s2, s77
    s_lshl_b32 s77, s77, 6
    v_add_u32 v24, s77, v24
    v_mul_u32_u24 v24, 3072, v24
    v_lshl_add_u32 v24, v25, 4, v24
    s_lshl_b32 s76, s76, 7
    s_add_u32 s76, s76, 0xc00000
    s_waitcnt lgkmcnt(0)
    buffer_store_dwordx4 v[30:33], v24, s[52:55], s76 offen offset:0 sc1
    buffer_store_dwordx4 v[34:37], v24, s[52:55], s76 offen offset:64 sc1
    s_add_u32 s76, s76, 49152
    buffer_store_dwordx4 v[38:41], v24, s[52:55], s76 offen offset:0 sc1
    buffer_store_dwordx4 v[42:45], v24, s[52:55], s76 offen offset:64 sc1
    s_add_u32 s76, s76, 49152
    buffer_store_dwordx4 v[46:49], v24, s[52:55], s76 offen offset:0 sc1
    buffer_store_dwordx4 v[50:53], v24, s[52:55], s76 offen offset:64 sc1
    s_add_u32 s76, s76, 49152
    buffer_store_dwordx4 v[54:57], v24, s[52:55], s76 offen offset:0 sc1
    buffer_store_dwordx4 v[58:61], v24, s[52:55], s76 offen offset:64 sc1
    s_mov_b32 s76, 0
k1_now2b:
    s_cmp_eq_u32 s76, 27
    s_cbranch_scc0 k1_now2c
    s_cmp_ge_u32 s2, 240
    s_cbranch_scc1 k1_now2c
    s_waitcnt vmcnt(0)
    s_lshl_b32 s76, s2, 7
    s_add_u32 s76, s76, 0xb50000
    v_mov_b32 v30, 1
    v_mov_b32 v31, 0
    s_mov_b64 exec, 1
    buffer_store_dword v30, v31, s[52:55], s76 offen sc1
    s_mov_b64 exec, -1
k1_now2c:
    s_cmp_lt_u32 s72, 9
    s_cbranch_scc1 k1_loop
    s_waitcnt lgkmcnt(0)
    v_mfma_f32_16x16x32_bf16 v[64:67], a[0:3], a[8:11], v[64:67]
    ds_read_b128 a[52:55], v13 offset:0
    v_mfma_f32_16x16x32_bf16 v[68:71], a[4:7], a[8:11], v[68:71]
    ds_read_b128 a[56:59], v13 offset:512
    v_mfma_f32_16x16x32_bf16 v[72:75], a[0:3], a[12:15], v[72:75]
    ds_read_b128 a[60:63], v15 offset:0
    v_mfma_f32_16x16x32_bf16 v[76:79], a[4:7], a[12:15], v[76:79]
    ds_read_b128 a[64:67], v15 offset:1024
    v_mfma_f32_16x16x32_bf16 v[80:83], a[0:3], a[16:19], v[80:83]
    ds_read_b128 a[68:71], v15 offset:2048
    v_mfma_f32_16x16x32_bf16 v[84:87], a[4:7], a[16:19], v[84:87]
    ds_read_b128 a[72:75], v15 offset:3072
    v_mfma_f32_16x16x32_bf16 v[88:91], a[0:3], a[20:23], v[88:91]
    ds_read_b128 a[76:79], v15 offset:4096
    v_mfma_f32_16x16x32_bf16 v[92:95], a[4:7], a[20:23], v[92:95]
    v_mfma_f32_16x16x32_bf16 v[96:99], a[0:3], a[24:27], v[96:99]
    ds_read_b64_tr_b16 a[80:81], v16 offset:6144
    v_mfma_f32_16x16x32_bf16 v[100:103], a[4:7], a[24:27], v[100:103]
    ds_read_b64_tr_b16 a[82:83], v16 offset:6912
    v_mfma_f32_16x16x32_bf16 v[104:107], a[0:3], a[28:31], v[104:107]
    ds_read_b64_tr_b16 a[84:85], v16 offset:6176
    v_mfma_f32_16x16x32_bf16 v[108:111], a[4:7], a[28:31], v[108:111]
    ds_read_b64_tr_b16 a[86:87], v16 offset:6944
    v_mfma_f32_16x16x32_bf16 v[112:115], a[0:3], a[32:35], v[112:115]
    ds_read_b64_tr_b16 a[88:89], v16 offset:6208
    v_mfma_f32_16x16x32_bf16 v[116:119], a[4:7], a[32:35], v[116:119]
    ds_read_b64_tr_b16 a[90:91], v16 offset:6976
    v_mfma_f32_16x16x32_bf16 v[120:123], a[0:3], a[36:39], v[120:123]
    v_mfma_f32_16x16x32_bf16 v[124:127], a[4:7], a[36:39], v[124:127]
    ds_read_b64_tr_b16 a[92:93], v16 offset:6240
    v_mfma_f32_16x16x32_bf16 v[128:131], a[0:3], a[40:43], v[128:131]
    ds_read_b64_tr_b16 a[94:95], v16 offset:7008
    v_mfma_f32_16x16x32_bf16 v[132:135], a[4:7], a[40:43], v[132:135]
    ds_read_b64_tr_b16 a[96:97], v16 offset:6272
    v_mfma_f32_16x16x32_bf16 v[136:139], a[0:3], a[44:47], v[136:139]
    ds_read_b64_tr_b16 a[98:99], v16 offset:7040
    v_mfma_f32_16x16x32_bf16 v[140:143], a[4:7], a[44:47], v[140:143]
    ds_read_b64_tr_b16 a[100:101], v17 offset:6144
    v_mfma_f32_16x16x32_bf16 v[144:147], a[0:3], a[48:51], v[144:147]
    ds_read_b64_tr_b16 a[102:103], v17 offset:6912
    v_mfma_f32_16x16x32_bf16 v[148:151], a[4:7], a[48:51], v[148:151]
    s_waitcnt lgkmcnt(0)
    v_mfma_f32_16x16x32_bf16 v[64:67], a[52:55], a[60:63], v[64:67]
    v_mfma_f32_16x16x32_bf16 v[68:71], a[56:59], a[60:63], v[68:71]
    v_mfma_f32_16x16x32_bf16 v[72:75], a[52:55], a[64:67], v[72:75]
    v_mfma_f32_16x16x32_bf16 v[76:79], a[56:59], a[64:67], v[76:79]
    v_mfma_f32_16x16x32_bf16 v[80:83], a[52:55], a[68:71], v[80:83]
    v_mfma_f32_16x16x32_bf16 v[84:87], a[56:59], a[68:71], v[84:87]
    v_mfma_f32_16x16x32_bf16 v[88:91], a[52:55], a[72:75], v[88:91]
    v_mfma_f32_16x16x32_bf16 v[92:95], a[56:59], a[72:75], v[92:95]
    v_mfma_f32_16x16x32_bf16 v[96:99], a[52:55], a[76:79], v[96:99]
    v_mfma_f32_16x16x32_bf16 v[100:103], a[56:59], a[76:79], v[100:103]
    v_mfma_f32_16x16x32_bf16 v[104:107], a[52:55], a[80:83], v[104:107]
    v_mfma_f32_16x16x32_bf16 v[108:111], a[56:59], a[80:83], v[108:111]
    v_mfma_f32_16x16x32_bf16 v[112:115], a[52:55], a[84:87], v[112:115]
    v_mfma_f32_16x16x32_bf16 v[116:119], a[56:59], a[84:87], v[116:119]
    v_mfma_f32_16x16x32_bf16 v[120:123], a[52:55], a[88:91], v[120:123]
    v_mfma_f32_16x16x32_bf16 v[124:127], a[56:59], a[88:91], v[124:127]
    v_mfma_f32_16x16x32_bf16 v[128:131], a[52:55], a[92:95], v[128:131]
    v_mfma_f32_16x16x32_bf16 v[132:135], a[56:59], a[92:95], v[132:135]
    v_mfma_f32_16x16x32_bf16 v[136:139], a[52:55], a[96:99], v[136:139]
    v_mfma_f32_16x16x32_bf16 v[140:143], a[56:59], a[96:99], v[140:143]
    v_mfma_f32_16x16x32_bf16 v[144:147], a[52:55], a[100:103], v[144:147]
    v_mfma_f32_16x16x32_bf16 v[148:151], a[56:59], a[100:103], v[148:151]
    s_nop 9
    v_bfe_u32 v55, v1, 1, 3
    v_lshlrev_b32 v55, 5, v55
    v_add_u32 v55, 156672, v55
    ds_read_b128 v[2:5], v55 offset:0
    ds_read_b128 v[6:9], v55 offset:256
    ds_read_b128 v[10:13], v55 offset:512
    ds_read_b128 v[14:17], v55 offset:768
    ds_read_b128 v[60:63], v55 offset:1024
    v_and_b32 v56, 1, v1
    v_cmp_eq_u32 vcc, 1, v56
    s_waitcnt lgkmcnt(0)
    v_mov_b32 v24, v2
    v_sub_f32 v57, 0, v3
    v_cndmask_b32 v29, v57, v3, vcc
    v_add_f32 v57, v4, v4
    v_sub_f32 v58, 0, v57
    v_cndmask_b32 v34, v57, v58, vcc
    v_mul_f32 v39, -2.0, v5
    v_mov_b32 v25, v6
    v_sub_f32 v57, 0, v7
    v_cndmask_b32 v30, v57, v7, vcc
    v_add_f32 v57, v8, v8
    v_sub_f32 v58, 0, v57
    v_cndmask_b32 v35, v57, v58, vcc
    v_mul_f32 v40, -2.0, v9
    v_mov_b32 v26, v10
    v_sub_f32 v57, 0, v11
    v_cndmask_b32 v31, v57, v11, vcc
    v_add_f32 v57, v12, v12
    v_sub_f32 v58, 0, v57
    v_cndmask_b32 v36, v57, v58, vcc
    v_mul_f32 v41, -2.0, v13
    v_mov_b32 v27, v14
    v_sub_f32 v57, 0, v15
    v_cndmask_b32 v32, v57, v15, vcc
    v_add_f32 v57, v16, v16
    v_sub_f32 v58, 0, v57
    v_cndmask_b32 v37, v57, v58, vcc
    v_mul_f32 v42, -2.0, v17
    v_mov_b32 v28, v60
    v_sub_f32 v57, 0, v61
    v_cndmask_b32 v33, v57, v61, vcc
    v_add_f32 v57, v62, v62
    v_sub_f32 v58, 0, v57
    v_cndmask_b32 v38, v57, v58, vcc
    v_mul_f32 v43, -2.0, v63
    v_fmac_f32 v65, v24, v64
    v_fmac_f32 v73, v25, v72
    v_fmac_f32 v81, v26, v80
    v_fmac_f32 v89, v27, v88
    v_fmac_f32 v97, v28, v96
    v_fmac_f32_dpp v65, v64, v29 quad_perm:[1,0,3,2] row_mask:0xf bank_mask:0xf
    v_fmac_f32_dpp v73, v72, v30 quad_perm:[1,0,3,2] row_mask:0xf bank_mask:0xf
    v_fmac_f32_dpp v81, v80, v31 quad_perm:[1,0,3,2] row_mask:0xf bank_mask:0xf
    v_fmac_f32_dpp v89, v88, v32 quad_perm:[1,0,3,2] row_mask:0xf bank_mask:0xf
    v_fmac_f32_dpp v97, v96, v33 quad_perm:[1,0,3,2] row_mask:0xf bank_mask:0xf
    v_fmac_f32 v66, v24, v65
    v_fmac_f32 v74, v25, v73
    v_fmac_f32 v82, v26, v81
    v_fmac_f32 v90, v27, v89
    v_fmac_f32 v98, v28, v97
    v_fmac_f32_dpp v66, v65, v29 quad_perm:[1,0,3,2] row_mask:0xf bank_mask:0xf
    v_fmac_f32_dpp v74, v73, v30 quad_perm:[1,0,3,2] row_mask:0xf bank_mask:0xf
    v_fmac_f32_dpp v82, v81, v31 quad_perm:[1,0,3,2] row_mask:0xf bank_mask:0xf
    v_fmac_f32_dpp v90, v89, v32 quad_perm:[1,0,3,2] row_mask:0xf bank_mask:0xf
    v_fmac_f32_dpp v98, v97, v33 quad_perm:[1,0,3,2] row_mask:0xf bank_mask:0xf
    v_fmac_f32 v67, v24, v66
    v_fmac_f32 v75, v25, v74
    v_fmac_f32 v83, v26, v82
    v_fmac_f32 v91, v27, v90
    v_fmac_f32 v99, v28, v98
    v_fmac_f32_dpp v67, v66, v29 quad_perm:[1,0,3,2] row_mask:0xf bank_mask:0xf
    v_fmac_f32_dpp v75, v74, v30 quad_perm:[1,0,3,2] row_mask:0xf bank_mask:0xf
    v_fmac_f32_dpp v83, v82, v31 quad_perm:[1,0,3,2] row_mask:0xf bank_mask:0xf
    v_fmac_f32_dpp v91, v90, v32 quad_perm:[1,0,3,2] row_mask:0xf bank_mask:0xf
    v_fmac_f32_dpp v99, v98, v33 quad_perm:[1,0,3,2] row_mask:0xf bank_mask:0xf
    v_fmac_f32 v68, v24, v67
    v_fmac_f32 v76, v25, v75
    v_fmac_f32 v84, v26, v83
    v_fmac_f32 v92, v27, v91
    v_fmac_f32 v100, v28, v99
    v_fmac_f32_dpp v68, v67, v29 quad_perm:[1,0,3,2] row_mask:0xf bank_mask:0xf
    v_fmac_f32_dpp v76, v75, v30 quad_perm:[1,0,3,2] row_mask:0xf bank_mask:0xf
    v_fmac_f32_dpp v84, v83, v31 quad_perm:[1,0,3,2] row_mask:0xf bank_mask:0xf
    v_fmac_f32_dpp v92, v91, v32 quad_perm:[1,0,3,2] row_mask:0xf bank_mask:0xf
    v_fmac_f32_dpp v100, v99, v33 quad_perm:[1,0,3,2] row_mask:0xf bank_mask:0xf
    v_fmac_f32 v69, v24, v68
    v_fmac_f32 v77, v25, v76
    v_fmac_f32 v85, v26, v84
    v_fmac_f32 v93, v27, v92
    v_fmac_f32 v101, v28, v100
    v_fmac_f32_dpp v69, v68, v29 quad_perm:[1,0,3,2] row_mask:0xf bank_mask:0xf
    v_fmac_f32_dpp v77, v76, v30 quad_perm:[1,0,3,2] row_mask:0xf bank_mask:0xf
    v_fmac_f32_dpp v85, v84, v31 quad_perm:[1,0,3,2] row_mask:0xf bank_mask:0xf
    v_fmac_f32_dpp v93, v92, v32 quad_perm:[1,0,3,2] row_mask:0xf bank_mask:0xf
    v_fmac_f32_dpp v101, v100, v33 quad_perm:[1,0,3,2] row_mask:0xf bank_mask:0xf
    v_fmac_f32 v70, v24, v69
    v_fmac_f32 v78, v25, v77
    v_fmac_f32 v86, v26, v85
    v_fmac_f32 v94, v27, v93
    v_fmac_f32 v102, v28, v101
    v_fmac_f32_dpp v70, v69, v29 quad_perm:[1,0,3,2] row_mask:0xf bank_mask:0xf
    v_fmac_f32_dpp v78, v77, v30 quad_perm:[1,0,3,2] row_mask:0xf bank_mask:0xf
    v_fmac_f32_dpp v86, v85, v31 quad_perm:[1,0,3,2] row_mask:0xf bank_mask:0xf
    v_fmac_f32_dpp v94, v93, v32 quad_perm:[1,0,3,2] row_mask:0xf bank_mask:0xf
    v_fmac_f32_dpp v102, v101, v33 quad_perm:[1,0,3,2] row_mask:0xf bank_mask:0xf
    v_fmac_f32 v71, v24, v70
    v_fmac_f32 v79, v25, v78
    v_fmac_f32 v87, v26, v86
    v_fmac_f32 v95, v27, v94
    v_fmac_f32 v103, v28, v102
    v_fmac_f32_dpp v71, v70, v29 quad_perm:[1,0,3,2] row_mask:0xf bank_mask:0xf
    v_fmac_f32_dpp v79, v78, v30 quad_perm:[1,0,3,2] row_mask:0xf bank_mask:0xf
    v_fmac_f32_dpp v87, v86, v31 quad_perm:[1,0,3,2] row_mask:0xf bank_mask:0xf
    v_fmac_f32_dpp v95, v94, v32 quad_perm:[1,0,3,2] row_mask:0xf bank_mask:0xf
    v_fmac_f32_dpp v103, v102, v33 quad_perm:[1,0,3,2] row_mask:0xf bank_mask:0xf
    v_lshrrev_b32 v55, 4, v1
    s_lshl_b32 s76, s66, 2
    v_add_u32 v55, s76, v55
    v_mul_u32_u24 v55, 320, v55
    v_and_b32 v56, 15, v1
    v_lshl_add_u32 v55, v56, 2, v55
    v_add_u32 v44, 151552, v55
    ds_write_b32 v44, v71 offset:0
    ds_write_b32 v44, v79 offset:64
    ds_write_b32 v44, v87 offset:128
    ds_write_b32 v44, v95 offset:192
    ds_write_b32 v44, v103 offset:256
    s_waitcnt lgkmcnt(0)
    s_barrier
    s_lshl_b32 s76, s64, 7
    s_lshl_b32 s77, s66, 5
    s_add_u32 s76, s76, s77
    v_lshrrev_b32 v56, 4, v1
    v_lshlrev_b32 v56, 3, v56
    v_add_u32 v56, s76, v56
    v_lshrrev_b32 v57, 6, v56
    v_mul_u32_u24 v57, 360448, v57
    v_and_b32 v56, 63, v56
    v_lshl_add_u32 v46, v56, 1, v57
    s_mul_i32 s76, s65, 96
    s_add_u32 s76, s76, 1280
    v_and_b32 v55, 15, v1
    v_add_u32 v55, s76, v55
    v_lshlrev_b32 v55, 7, v55
    v_add_u32 v45, v55, v46
    s_mov_b32 s76, 0x3fb8aa3b
    s_mov_b32 s77, 0x3f317218
    s_mov_b32 s82, 0
    s_waitcnt vmcnt(0)
    v_lshlrev_b32 v18, 16, v18
    v_cvt_pk_bf16_f32 v63, v104, v105
    v_lshlrev_b32 v55, 16, v63
    v_and_b32 v56, 0xffff0000, v63
    v_add_f32 v55, v55, v18
    v_add_f32 v56, v56, v18
    v_cvt_pk_bf16_f32 v63, v55, v56
    v_lshlrev_b32 v55, 16, v63
    v_and_b32 v56, 0xffff0000, v63
    v_mul_f32 v57, s76, -abs(v55)
    v_mul_f32 v58, s76, -abs(v56)
    v_exp_f32 v57, v57
    v_exp_f32 v58, v58
    v_cmp_le_f32 vcc, 0, v55
    v_cmp_le_f32 s[78:79], 0, v56
    v_mul_f32 v59, v57, v57
    v_mul_f32 v60, v58, v58
    v_cndmask_b32 v61, v59, 1.0, vcc
    v_cndmask_b32 v62, v60, 1.0, s[78:79]
    v_cndmask_b32 v59, 1.0, v59, vcc
    v_cndmask_b32 v60, 1.0, v60, s[78:79]
    v_fma_f32 v61, v57, 2.0, v61
    v_fma_f32 v62, v58, 2.0, v62
    v_fma_f32 v59, v59, 2.0, v61
    v_fma_f32 v60, v60, 2.0, v62
    v_rcp_f32 v59, v59
    v_rcp_f32 v60, v60
    v_mul_f32 v61, v61, v55
    v_mul_f32 v62, v62, v56
    v_mul_f32 v57, v61, v59
    v_mul_f32 v58, v62, v60
    v_cvt_pk_bf16_f32 v104, v57, v58
    v_cvt_pk_bf16_f32 v63, v106, v107
    v_lshlrev_b32 v55, 16, v63
    v_and_b32 v56, 0xffff0000, v63
    v_add_f32 v55, v55, v18
    v_add_f32 v56, v56, v18
    v_cvt_pk_bf16_f32 v63, v55, v56
    v_lshlrev_b32 v55, 16, v63
    v_and_b32 v56, 0xffff0000, v63
    v_mul_f32 v57, s76, -abs(v55)
    v_mul_f32 v58, s76, -abs(v56)
    v_exp_f32 v57, v57
    v_exp_f32 v58, v58
    v_cmp_le_f32 vcc, 0, v55
    v_cmp_le_f32 s[78:79], 0, v56
    v_mul_f32 v59, v57, v57
    v_mul_f32 v60, v58, v58
    v_cndmask_b32 v61, v59, 1.0, vcc
    v_cndmask_b32 v62, v60, 1.0, s[78:79]
    v_cndmask_b32 v59, 1.0, v59, vcc
    v_cndmask_b32 v60, 1.0, v60, s[78:79]
    v_fma_f32 v61, v57, 2.0, v61
    v_fma_f32 v62, v58, 2.0, v62
    v_fma_f32 v59, v59, 2.0, v61
    v_fma_f32 v60, v60, 2.0, v62
    v_rcp_f32 v59, v59
    v_rcp_f32 v60, v60
    v_mul_f32 v61, v61, v55
    v_mul_f32 v62, v62, v56
    v_mul_f32 v57, v61, v59
    v_mul_f32 v58, v62, v60
    v_cvt_pk_bf16_f32 v105, v57, v58
    v_cvt_pk_bf16_f32 v63, v108, v109
    v_lshlrev_b32 v55, 16, v63
    v_and_b32 v56, 0xffff0000, v63
    v_add_f32 v55, v55, v18
    v_add_f32 v56, v56, v18
    v_cvt_pk_bf16_f32 v63, v55, v56
    v_lshlrev_b32 v55, 16, v63
    v_and_b32 v56, 0xffff0000, v63
    v_mul_f32 v57, s76, -abs(v55)
    v_mul_f32 v58, s76, -abs(v56)
    v_exp_f32 v57, v57
    v_exp_f32 v58, v58
    v_cmp_le_f32 vcc, 0, v55
    v_cmp_le_f32 s[78:79], 0, v56
    v_mul_f32 v59, v57, v57
    v_mul_f32 v60, v58, v58
    v_cndmask_b32 v61, v59, 1.0, vcc
    v_cndmask_b32 v62, v60, 1.0, s[78:79]
    v_cndmask_b32 v59, 1.0, v59, vcc
    v_cndmask_b32 v60, 1.0, v60, s[78:79]
    v_fma_f32 v61, v57, 2.0, v61
    v_fma_f32 v62, v58, 2.0, v62
    v_fma_f32 v59, v59, 2.0, v61
    v_fma_f32 v60, v60, 2.0, v62
    v_rcp_f32 v59, v59
    v_rcp_f32 v60, v60
    v_mul_f32 v61, v61, v55
    v_mul_f32 v62, v62, v56
    v_mul_f32 v57, v61, v59
    v_mul_f32 v58, v62, v60
    v_cvt_pk_bf16_f32 v106, v57, v58
    v_cvt_pk_bf16_f32 v63, v110, v111
    v_lshlrev_b32 v55, 16, v63
    v_and_b32 v56, 0xffff0000, v63
    v_add_f32 v55, v55, v18
    v_add_f32 v56, v56, v18
    v_cvt_pk_bf16_f32 v63, v55, v56
    v_lshlrev_b32 v55, 16, v63
    v_and_b32 v56, 0xffff0000, v63
    v_mul_f32 v57, s76, -abs(v55)
    v_mul_f32 v58, s76, -abs(v56)
    v_exp_f32 v57, v57
    v_exp_f32 v58, v58
    v_cmp_le_f32 vcc, 0, v55
    v_cmp_le_f32 s[78:79], 0, v56
    v_mul_f32 v59, v57, v57
    v_mul_f32 v60, v58, v58
    v_cndmask_b32 v61, v59, 1.0, vcc
    v_cndmask_b32 v62, v60, 1.0, s[78:79]
    v_cndmask_b32 v59, 1.0, v59, vcc
    v_cndmask_b32 v60, 1.0, v60, s[78:79]
    v_fma_f32 v61, v57, 2.0, v61
    v_fma_f32 v62, v58, 2.0, v62
    v_fma_f32 v59, v59, 2.0, v61
    v_fma_f32 v60, v60, 2.0, v62
    v_rcp_f32 v59, v59
    v_rcp_f32 v60, v60
    v_mul_f32 v61, v61, v55
    v_mul_f32 v62, v62, v56
    v_mul_f32 v57, v61, v59
    v_mul_f32 v58, v62, v60
    v_cvt_pk_bf16_f32 v107, v57, v58
    buffer_store_dwordx4 v[104:107], v45, s[52:55], s82 offen sc1
    s_add_u32 s82, s82, 2048
    v_lshlrev_b32 v19, 16, v19
    v_cvt_pk_bf16_f32 v63, v112, v113
    v_lshlrev_b32 v55, 16, v63
    v_and_b32 v56, 0xffff0000, v63
    v_add_f32 v55, v55, v19
    v_add_f32 v56, v56, v19
    v_cvt_pk_bf16_f32 v63, v55, v56
    v_lshlrev_b32 v55, 16, v63
    v_and_b32 v56, 0xffff0000, v63
    v_mul_f32 v57, s76, -abs(v55)
    v_mul_f32 v58, s76, -abs(v56)
    v_exp_f32 v57, v57
    v_exp_f32 v58, v58
    v_cmp_le_f32 vcc, 0, v55
    v_cmp_le_f32 s[78:79], 0, v56
    v_mul_f32 v59, v57, v57
    v_mul_f32 v60, v58, v58
    v_cndmask_b32 v61, v59, 1.0, vcc
    v_cndmask_b32 v62, v60, 1.0, s[78:79]
    v_cndmask_b32 v59, 1.0, v59, vcc
    v_cndmask_b32 v60, 1.0, v60, s[78:79]
    v_fma_f32 v61, v57, 2.0, v61
    v_fma_f32 v62, v58, 2.0, v62
    v_fma_f32 v59, v59, 2.0, v61
    v_fma_f32 v60, v60, 2.0, v62
    v_rcp_f32 v59, v59
    v_rcp_f32 v60, v60
    v_mul_f32 v61, v61, v55
    v_mul_f32 v62, v62, v56
    v_mul_f32 v57, v61, v59
    v_mul_f32 v58, v62, v60
    v_cvt_pk_bf16_f32 v112, v57, v58
    v_cvt_pk_bf16_f32 v63, v114, v115
    v_lshlrev_b32 v55, 16, v63
    v_and_b32 v56, 0xffff0000, v63
    v_add_f32 v55, v55, v19
    v_add_f32 v56, v56, v19
    v_cvt_pk_bf16_f32 v63, v55, v56
    v_lshlrev_b32 v55, 16, v63
    v_and_b32 v56, 0xffff0000, v63
    v_mul_f32 v57, s76, -abs(v55)
    v_mul_f32 v58, s76, -abs(v56)
    v_exp_f32 v57, v57
    v_exp_f32 v58, v58
    v_cmp_le_f32 vcc, 0, v55
    v_cmp_le_f32 s[78:79], 0, v56
    v_mul_f32 v59, v57, v57
    v_mul_f32 v60, v58, v58
    v_cndmask_b32 v61, v59, 1.0, vcc
    v_cndmask_b32 v62, v60, 1.0, s[78:79]
    v_cndmask_b32 v59, 1.0, v59, vcc
    v_cndmask_b32 v60, 1.0, v60, s[78:79]
    v_fma_f32 v61, v57, 2.0, v61
    v_fma_f32 v62, v58, 2.0, v62
    v_fma_f32 v59, v59, 2.0, v61
    v_fma_f32 v60, v60, 2.0, v62
    v_rcp_f32 v59, v59
    v_rcp_f32 v60, v60
    v_mul_f32 v61, v61, v55
    v_mul_f32 v62, v62, v56
    v_mul_f32 v57, v61, v59
    v_mul_f32 v58, v62, v60
    v_cvt_pk_bf16_f32 v113, v57, v58
    v_cvt_pk_bf16_f32 v63, v116, v117
    v_lshlrev_b32 v55, 16, v63
    v_and_b32 v56, 0xffff0000, v63
    v_add_f32 v55, v55, v19
    v_add_f32 v56, v56, v19
    v_cvt_pk_bf16_f32 v63, v55, v56
    v_lshlrev_b32 v55, 16, v63
    v_and_b32 v56, 0xffff0000, v63
    v_mul_f32 v57, s76, -abs(v55)
    v_mul_f32 v58, s76, -abs(v56)
    v_exp_f32 v57, v57
    v_exp_f32 v58, v58
    v_cmp_le_f32 vcc, 0, v55
    v_cmp_le_f32 s[78:79], 0, v56
    v_mul_f32 v59, v57, v57
    v_mul_f32 v60, v58, v58
    v_cndmask_b32 v61, v59, 1.0, vcc
    v_cndmask_b32 v62, v60, 1.0, s[78:79]
    v_cndmask_b32 v59, 1.0, v59, vcc
    v_cndmask_b32 v60, 1.0, v60, s[78:79]
    v_fma_f32 v61, v57, 2.0, v61
    v_fma_f32 v62, v58, 2.0, v62
    v_fma_f32 v59, v59, 2.0, v61
    v_fma_f32 v60, v60, 2.0, v62
    v_rcp_f32 v59, v59
    v_rcp_f32 v60, v60
    v_mul_f32 v61, v61, v55
    v_mul_f32 v62, v62, v56
    v_mul_f32 v57, v61, v59
    v_mul_f32 v58, v62, v60
    v_cvt_pk_bf16_f32 v114, v57, v58
    v_cvt_pk_bf16_f32 v63, v118, v119
    v_lshlrev_b32 v55, 16, v63
    v_and_b32 v56, 0xffff0000, v63
    v_add_f32 v55, v55, v19
    v_add_f32 v56, v56, v19
    v_cvt_pk_bf16_f32 v63, v55, v56
    v_lshlrev_b32 v55, 16, v63
    v_and_b32 v56, 0xffff0000, v63
    v_mul_f32 v57, s76, -abs(v55)
    v_mul_f32 v58, s76, -abs(v56)
    v_exp_f32 v57, v57
    v_exp_f32 v58, v58
    v_cmp_le_f32 vcc, 0, v55
    v_cmp_le_f32 s[78:79], 0, v56
    v_mul_f32 v59, v57, v57
    v_mul_f32 v60, v58, v58
    v_cndmask_b32 v61, v59, 1.0, vcc
    v_cndmask_b32 v62, v60, 1.0, s[78:79]
    v_cndmask_b32 v59, 1.0, v59, vcc
    v_cndmask_b32 v60, 1.0, v60, s[78:79]
    v_fma_f32 v61, v57, 2.0, v61
    v_fma_f32 v62, v58, 2.0, v62
    v_fma_f32 v59, v59, 2.0, v61
    v_fma_f32 v60, v60, 2.0, v62
    v_rcp_f32 v59, v59
    v_rcp_f32 v60, v60
    v_mul_f32 v61, v61, v55
    v_mul_f32 v62, v62, v56
    v_mul_f32 v57, v61, v59
    v_mul_f32 v58, v62, v60
    v_cvt_pk_bf16_f32 v115, v57, v58
    buffer_store_dwordx4 v[112:115], v45, s[52:55], s82 offen sc1
    s_add_u32 s82, s82, 2048
    v_lshlrev_b32 v20, 16, v20
    v_cvt_pk_bf16_f32 v63, v120, v121
    v_lshlrev_b32 v55, 16, v63
    v_and_b32 v56, 0xffff0000, v63
    v_add_f32 v55, v55, v20
    v_add_f32 v56, v56, v20
    v_cvt_pk_bf16_f32 v63, v55, v56
    v_lshlrev_b32 v55, 16, v63
    v_and_b32 v56, 0xffff0000, v63
    v_mul_f32 v57, s76, -abs(v55)
    v_mul_f32 v58, s76, -abs(v56)
    v_exp_f32 v57, v57
    v_exp_f32 v58, v58
    v_cmp_le_f32 vcc, 0, v55
    v_cmp_le_f32 s[78:79], 0, v56
    v_mul_f32 v59, v57, v57
    v_mul_f32 v60, v58, v58
    v_cndmask_b32 v61, v59, 1.0, vcc
    v_cndmask_b32 v62, v60, 1.0, s[78:79]
    v_cndmask_b32 v59, 1.0, v59, vcc
    v_cndmask_b32 v60, 1.0, v60, s[78:79]
    v_fma_f32 v61, v57, 2.0, v61
    v_fma_f32 v62, v58, 2.0, v62
    v_fma_f32 v59, v59, 2.0, v61
    v_fma_f32 v60, v60, 2.0, v62
    v_rcp_f32 v59, v59
    v_rcp_f32 v60, v60
    v_mul_f32 v61, v61, v55
    v_mul_f32 v62, v62, v56
    v_mul_f32 v57, v61, v59
    v_mul_f32 v58, v62, v60
    v_cvt_pk_bf16_f32 v120, v57, v58
    v_cvt_pk_bf16_f32 v63, v122, v123
    v_lshlrev_b32 v55, 16, v63
    v_and_b32 v56, 0xffff0000, v63
    v_add_f32 v55, v55, v20
    v_add_f32 v56, v56, v20
    v_cvt_pk_bf16_f32 v63, v55, v56
    v_lshlrev_b32 v55, 16, v63
    v_and_b32 v56, 0xffff0000, v63
    v_mul_f32 v57, s76, -abs(v55)
    v_mul_f32 v58, s76, -abs(v56)
    v_exp_f32 v57, v57
    v_exp_f32 v58, v58
    v_cmp_le_f32 vcc, 0, v55
    v_cmp_le_f32 s[78:79], 0, v56
    v_mul_f32 v59, v57, v57
    v_mul_f32 v60, v58, v58
    v_cndmask_b32 v61, v59, 1.0, vcc
    v_cndmask_b32 v62, v60, 1.0, s[78:79]
    v_cndmask_b32 v59, 1.0, v59, vcc
    v_cndmask_b32 v60, 1.0, v60, s[78:79]
    v_fma_f32 v61, v57, 2.0, v61
    v_fma_f32 v62, v58, 2.0, v62
    v_fma_f32 v59, v59, 2.0, v61
    v_fma_f32 v60, v60, 2.0, v62
    v_rcp_f32 v59, v59
    v_rcp_f32 v60, v60
    v_mul_f32 v61, v61, v55
    v_mul_f32 v62, v62, v56
    v_mul_f32 v57, v61, v59
    v_mul_f32 v58, v62, v60
    v_cvt_pk_bf16_f32 v121, v57, v58
    v_cvt_pk_bf16_f32 v63, v124, v125
    v_lshlrev_b32 v55, 16, v63
    v_and_b32 v56, 0xffff0000, v63
    v_add_f32 v55, v55, v20
    v_add_f32 v56, v56, v20
    v_cvt_pk_bf16_f32 v63, v55, v56
    v_lshlrev_b32 v55, 16, v63
    v_and_b32 v56, 0xffff0000, v63
    v_mul_f32 v57, s76, -abs(v55)
    v_mul_f32 v58, s76, -abs(v56)
    v_exp_f32 v57, v57
    v_exp_f32 v58, v58
    v_cmp_le_f32 vcc, 0, v55
    v_cmp_le_f32 s[78:79], 0, v56
    v_mul_f32 v59, v57, v57
    v_mul_f32 v60, v58, v58
    v_cndmask_b32 v61, v59, 1.0, vcc
    v_cndmask_b32 v62, v60, 1.0, s[78:79]
    v_cndmask_b32 v59, 1.0, v59, vcc
    v_cndmask_b32 v60, 1.0, v60, s[78:79]
    v_fma_f32 v61, v57, 2.0, v61
    v_fma_f32 v62, v58, 2.0, v62
    v_fma_f32 v59, v59, 2.0, v61
    v_fma_f32 v60, v60, 2.0, v62
    v_rcp_f32 v59, v59
    v_rcp_f32 v60, v60
    v_mul_f32 v61, v61, v55
    v_mul_f32 v62, v62, v56
    v_mul_f32 v57, v61, v59
    v_mul_f32 v58, v62, v60
    v_cvt_pk_bf16_f32 v122, v57, v58
    v_cvt_pk_bf16_f32 v63, v126, v127
    v_lshlrev_b32 v55, 16, v63
    v_and_b32 v56, 0xffff0000, v63
    v_add_f32 v55, v55, v20
    v_add_f32 v56, v56, v20
    v_cvt_pk_bf16_f32 v63, v55, v56
    v_lshlrev_b32 v55, 16, v63
    v_and_b32 v56, 0xffff0000, v63
    v_mul_f32 v57, s76, -abs(v55)
    v_mul_f32 v58, s76, -abs(v56)
    v_exp_f32 v57, v57
    v_exp_f32 v58, v58
    v_cmp_le_f32 vcc, 0, v55
    v_cmp_le_f32 s[78:79], 0, v56
    v_mul_f32 v59, v57, v57
    v_mul_f32 v60, v58, v58
    v_cndmask_b32 v61, v59, 1.0, vcc
    v_cndmask_b32 v62, v60, 1.0, s[78:79]
    v_cndmask_b32 v59, 1.0, v59, vcc
    v_cndmask_b32 v60, 1.0, v60, s[78:79]
    v_fma_f32 v61, v57, 2.0, v61
    v_fma_f32 v62, v58, 2.0, v62
    v_fma_f32 v59, v59, 2.0, v61
    v_fma_f32 v60, v60, 2.0, v62
    v_rcp_f32 v59, v59
    v_rcp_f32 v60, v60
    v_mul_f32 v61, v61, v55
    v_mul_f32 v62, v62, v56
    v_mul_f32 v57, v61, v59
    v_mul_f32 v58, v62, v60
    v_cvt_pk_bf16_f32 v123, v57, v58
    buffer_store_dwordx4 v[120:123], v45, s[52:55], s82 offen sc1
    s_add_u32 s82, s82, 2048
    v_lshlrev_b32 v21, 16, v21
    v_cvt_pk_bf16_f32 v63, v128, v129
    v_lshlrev_b32 v55, 16, v63
    v_and_b32 v56, 0xffff0000, v63
    v_add_f32 v55, v55, v21
    v_add_f32 v56, v56, v21
    v_cvt_pk_bf16_f32 v63, v55, v56
    v_lshlrev_b32 v55, 16, v63
    v_and_b32 v56, 0xffff0000, v63
    v_mul_f32 v57, s76, -abs(v55)
    v_mul_f32 v58, s76, -abs(v56)
    v_exp_f32 v57, v57
    v_exp_f32 v58, v58
    v_cmp_le_f32 vcc, 0, v55
    v_cmp_le_f32 s[78:79], 0, v56
    v_mul_f32 v59, v57, v57
    v_mul_f32 v60, v58, v58
    v_cndmask_b32 v61, v59, 1.0, vcc
    v_cndmask_b32 v62, v60, 1.0, s[78:79]
    v_cndmask_b32 v59, 1.0, v59, vcc
    v_cndmask_b32 v60, 1.0, v60, s[78:79]
    v_fma_f32 v61, v57, 2.0, v61
    v_fma_f32 v62, v58, 2.0, v62
    v_fma_f32 v59, v59, 2.0, v61
    v_fma_f32 v60, v60, 2.0, v62
    v_rcp_f32 v59, v59
    v_rcp_f32 v60, v60
    v_mul_f32 v61, v61, v55
    v_mul_f32 v62, v62, v56
    v_mul_f32 v57, v61, v59
    v_mul_f32 v58, v62, v60
    v_cvt_pk_bf16_f32 v128, v57, v58
    v_cvt_pk_bf16_f32 v63, v130, v131
    v_lshlrev_b32 v55, 16, v63
    v_and_b32 v56, 0xffff0000, v63
    v_add_f32 v55, v55, v21
    v_add_f32 v56, v56, v21
    v_cvt_pk_bf16_f32 v63, v55, v56
    v_lshlrev_b32 v55, 16, v63
    v_and_b32 v56, 0xffff0000, v63
    v_mul_f32 v57, s76, -abs(v55)
    v_mul_f32 v58, s76, -abs(v56)
    v_exp_f32 v57, v57
    v_exp_f32 v58, v58
    v_cmp_le_f32 vcc, 0, v55
    v_cmp_le_f32 s[78:79], 0, v56
    v_mul_f32 v59, v57, v57
    v_mul_f32 v60, v58, v58
    v_cndmask_b32 v61, v59, 1.0, vcc
    v_cndmask_b32 v62, v60, 1.0, s[78:79]
    v_cndmask_b32 v59, 1.0, v59, vcc
    v_cndmask_b32 v60, 1.0, v60, s[78:79]
    v_fma_f32 v61, v57, 2.0, v61
    v_fma_f32 v62, v58, 2.0, v62
    v_fma_f32 v59, v59, 2.0, v61
    v_fma_f32 v60, v60, 2.0, v62
    v_rcp_f32 v59, v59
    v_rcp_f32 v60, v60
    v_mul_f32 v61, v61, v55
    v_mul_f32 v62, v62, v56
    v_mul_f32 v57, v61, v59
    v_mul_f32 v58, v62, v60
    v_cvt_pk_bf16_f32 v129, v57, v58
    v_cvt_pk_bf16_f32 v63, v132, v133
    v_lshlrev_b32 v55, 16, v63
    v_and_b32 v56, 0xffff0000, v63
    v_add_f32 v55, v55, v21
    v_add_f32 v56, v56, v21
    v_cvt_pk_bf16_f32 v63, v55, v56
    v_lshlrev_b32 v55, 16, v63
    v_and_b32 v56, 0xffff0000, v63
    v_mul_f32 v57, s76, -abs(v55)
    v_mul_f32 v58, s76, -abs(v56)
    v_exp_f32 v57, v57
    v_exp_f32 v58, v58
    v_cmp_le_f32 vcc, 0, v55
    v_cmp_le_f32 s[78:79], 0, v56
    v_mul_f32 v59, v57, v57
    v_mul_f32 v60, v58, v58
    v_cndmask_b32 v61, v59, 1.0, vcc
    v_cndmask_b32 v62, v60, 1.0, s[78:79]
    v_cndmask_b32 v59, 1.0, v59, vcc
    v_cndmask_b32 v60, 1.0, v60, s[78:79]
    v_fma_f32 v61, v57, 2.0, v61
    v_fma_f32 v62, v58, 2.0, v62
    v_fma_f32 v59, v59, 2.0, v61
    v_fma_f32 v60, v60, 2.0, v62
    v_rcp_f32 v59, v59
    v_rcp_f32 v60, v60
    v_mul_f32 v61, v61, v55
    v_mul_f32 v62, v62, v56
    v_mul_f32 v57, v61, v59
    v_mul_f32 v58, v62, v60
    v_cvt_pk_bf16_f32 v130, v57, v58
    v_cvt_pk_bf16_f32 v63, v134, v135
    v_lshlrev_b32 v55, 16, v63
    v_and_b32 v56, 0xffff0000, v63
    v_add_f32 v55, v55, v21
    v_add_f32 v56, v56, v21
    v_cvt_pk_bf16_f32 v63, v55, v56
    v_lshlrev_b32 v55, 16, v63
    v_and_b32 v56, 0xffff0000, v63
    v_mul_f32 v57, s76, -abs(v55)
    v_mul_f32 v58, s76, -abs(v56)
    v_exp_f32 v57, v57
    v_exp_f32 v58, v58
    v_cmp_le_f32 vcc, 0, v55
    v_cmp_le_f32 s[78:79], 0, v56
    v_mul_f32 v59, v57, v57
    v_mul_f32 v60, v58, v58
    v_cndmask_b32 v61, v59, 1.0, vcc
    v_cndmask_b32 v62, v60, 1.0, s[78:79]
    v_cndmask_b32 v59, 1.0, v59, vcc
    v_cndmask_b32 v60, 1.0, v60, s[78:79]
    v_fma_f32 v61, v57, 2.0, v61
    v_fma_f32 v62, v58, 2.0, v62
    v_fma_f32 v59, v59, 2.0, v61
    v_fma_f32 v60, v60, 2.0, v62
    v_rcp_f32 v59, v59
    v_rcp_f32 v60, v60
    v_mul_f32 v61, v61, v55
    v_mul_f32 v62, v62, v56
    v_mul_f32 v57, v61, v59
    v_mul_f32 v58, v62, v60
    v_cvt_pk_bf16_f32 v131, v57, v58
    buffer_store_dwordx4 v[128:131], v45, s[52:55], s82 offen sc1
    s_add_u32 s82, s82, 2048
    v_lshlrev_b32 v22, 16, v22
    v_cvt_pk_bf16_f32 v63, v136, v137
    v_lshlrev_b32 v55, 16, v63
    v_and_b32 v56, 0xffff0000, v63
    v_add_f32 v55, v55, v22
    v_add_f32 v56, v56, v22
    v_cvt_pk_bf16_f32 v63, v55, v56
    v_lshlrev_b32 v55, 16, v63
    v_and_b32 v56, 0xffff0000, v63
    v_mul_f32 v57, s76, -abs(v55)
    v_mul_f32 v58, s76, -abs(v56)
    v_exp_f32 v57, v57
    v_exp_f32 v58, v58
    v_cmp_le_f32 vcc, 0, v55
    v_cmp_le_f32 s[78:79], 0, v56
    v_mul_f32 v59, v57, v57
    v_mul_f32 v60, v58, v58
    v_cndmask_b32 v61, v59, 1.0, vcc
    v_cndmask_b32 v62, v60, 1.0, s[78:79]
    v_cndmask_b32 v59, 1.0, v59, vcc
    v_cndmask_b32 v60, 1.0, v60, s[78:79]
    v_fma_f32 v61, v57, 2.0, v61
    v_fma_f32 v62, v58, 2.0, v62
    v_fma_f32 v59, v59, 2.0, v61
    v_fma_f32 v60, v60, 2.0, v62
    v_rcp_f32 v59, v59
    v_rcp_f32 v60, v60
    v_mul_f32 v61, v61, v55
    v_mul_f32 v62, v62, v56
    v_mul_f32 v57, v61, v59
    v_mul_f32 v58, v62, v60
    v_cvt_pk_bf16_f32 v136, v57, v58
    v_cvt_pk_bf16_f32 v63, v138, v139
    v_lshlrev_b32 v55, 16, v63
    v_and_b32 v56, 0xffff0000, v63
    v_add_f32 v55, v55, v22
    v_add_f32 v56, v56, v22
    v_cvt_pk_bf16_f32 v63, v55, v56
    v_lshlrev_b32 v55, 16, v63
    v_and_b32 v56, 0xffff0000, v63
    v_mul_f32 v57, s76, -abs(v55)
    v_mul_f32 v58, s76, -abs(v56)
    v_exp_f32 v57, v57
    v_exp_f32 v58, v58
    v_cmp_le_f32 vcc, 0, v55
    v_cmp_le_f32 s[78:79], 0, v56
    v_mul_f32 v59, v57, v57
    v_mul_f32 v60, v58, v58
    v_cndmask_b32 v61, v59, 1.0, vcc
    v_cndmask_b32 v62, v60, 1.0, s[78:79]
    v_cndmask_b32 v59, 1.0, v59, vcc
    v_cndmask_b32 v60, 1.0, v60, s[78:79]
    v_fma_f32 v61, v57, 2.0, v61
    v_fma_f32 v62, v58, 2.0, v62
    v_fma_f32 v59, v59, 2.0, v61
    v_fma_f32 v60, v60, 2.0, v62
    v_rcp_f32 v59, v59
    v_rcp_f32 v60, v60
    v_mul_f32 v61, v61, v55
    v_mul_f32 v62, v62, v56
    v_mul_f32 v57, v61, v59
    v_mul_f32 v58, v62, v60
    v_cvt_pk_bf16_f32 v137, v57, v58
    v_cvt_pk_bf16_f32 v63, v140, v141
    v_lshlrev_b32 v55, 16, v63
    v_and_b32 v56, 0xffff0000, v63
    v_add_f32 v55, v55, v22
    v_add_f32 v56, v56, v22
    v_cvt_pk_bf16_f32 v63, v55, v56
    v_lshlrev_b32 v55, 16, v63
    v_and_b32 v56, 0xffff0000, v63
    v_mul_f32 v57, s76, -abs(v55)
    v_mul_f32 v58, s76, -abs(v56)
    v_exp_f32 v57, v57
    v_exp_f32 v58, v58
    v_cmp_le_f32 vcc, 0, v55
    v_cmp_le_f32 s[78:79], 0, v56
    v_mul_f32 v59, v57, v57
    v_mul_f32 v60, v58, v58
    v_cndmask_b32 v61, v59, 1.0, vcc
    v_cndmask_b32 v62, v60, 1.0, s[78:79]
    v_cndmask_b32 v59, 1.0, v59, vcc
    v_cndmask_b32 v60, 1.0, v60, s[78:79]
    v_fma_f32 v61, v57, 2.0, v61
    v_fma_f32 v62, v58, 2.0, v62
    v_fma_f32 v59, v59, 2.0, v61
    v_fma_f32 v60, v60, 2.0, v62
    v_rcp_f32 v59, v59
    v_rcp_f32 v60, v60
    v_mul_f32 v61, v61, v55
    v_mul_f32 v62, v62, v56
    v_mul_f32 v57, v61, v59
    v_mul_f32 v58, v62, v60
    v_cvt_pk_bf16_f32 v138, v57, v58
    v_cvt_pk_bf16_f32 v63, v142, v143
    v_lshlrev_b32 v55, 16, v63
    v_and_b32 v56, 0xffff0000, v63
    v_add_f32 v55, v55, v22
    v_add_f32 v56, v56, v22
    v_cvt_pk_bf16_f32 v63, v55, v56
    v_lshlrev_b32 v55, 16, v63
    v_and_b32 v56, 0xffff0000, v63
    v_mul_f32 v57, s76, -abs(v55)
    v_mul_f32 v58, s76, -abs(v56)
    v_exp_f32 v57, v57
    v_exp_f32 v58, v58
    v_cmp_le_f32 vcc, 0, v55
    v_cmp_le_f32 s[78:79], 0, v56
    v_mul_f32 v59, v57, v57
    v_mul_f32 v60, v58, v58
    v_cndmask_b32 v61, v59, 1.0, vcc
    v_cndmask_b32 v62, v60, 1.0, s[78:79]
    v_cndmask_b32 v59, 1.0, v59, vcc
    v_cndmask_b32 v60, 1.0, v60, s[78:79]
    v_fma_f32 v61, v57, 2.0, v61
    v_fma_f32 v62, v58, 2.0, v62
    v_fma_f32 v59, v59, 2.0, v61
    v_fma_f32 v60, v60, 2.0, v62
    v_rcp_f32 v59, v59
    v_rcp_f32 v60, v60
    v_mul_f32 v61, v61, v55
    v_mul_f32 v62, v62, v56
    v_mul_f32 v57, v61, v59
    v_mul_f32 v58, v62, v60
    v_cvt_pk_bf16_f32 v139, v57, v58
    buffer_store_dwordx4 v[136:139], v45, s[52:55], s82 offen sc1
    s_add_u32 s82, s82, 2048
    v_lshlrev_b32 v23, 16, v23
    v_cvt_pk_bf16_f32 v63, v144, v145
    v_lshlrev_b32 v55, 16, v63
    v_and_b32 v56, 0xffff0000, v63
    v_add_f32 v55, v55, v23
    v_add_f32 v56, v56, v23
    v_cvt_pk_bf16_f32 v63, v55, v56
    v_lshlrev_b32 v55, 16, v63
    v_and_b32 v56, 0xffff0000, v63
    v_mul_f32 v57, s76, -abs(v55)
    v_mul_f32 v58, s76, -abs(v56)
    v_exp_f32 v57, v57
    v_exp_f32 v58, v58
    v_cmp_le_f32 vcc, 0, v55
    v_cmp_le_f32 s[78:79], 0, v56
    v_mul_f32 v59, v57, v57
    v_mul_f32 v60, v58, v58
    v_cndmask_b32 v61, v59, 1.0, vcc
    v_cndmask_b32 v62, v60, 1.0, s[78:79]
    v_cndmask_b32 v59, 1.0, v59, vcc
    v_cndmask_b32 v60, 1.0, v60, s[78:79]
    v_fma_f32 v61, v57, 2.0, v61
    v_fma_f32 v62, v58, 2.0, v62
    v_fma_f32 v59, v59, 2.0, v61
    v_fma_f32 v60, v60, 2.0, v62
    v_rcp_f32 v59, v59
    v_rcp_f32 v60, v60
    v_mul_f32 v61, v61, v55
    v_mul_f32 v62, v62, v56
    v_mul_f32 v57, v61, v59
    v_mul_f32 v58, v62, v60
    v_cvt_pk_bf16_f32 v144, v57, v58
    v_cvt_pk_bf16_f32 v63, v146, v147
    v_lshlrev_b32 v55, 16, v63
    v_and_b32 v56, 0xffff0000, v63
    v_add_f32 v55, v55, v23
    v_add_f32 v56, v56, v23
    v_cvt_pk_bf16_f32 v63, v55, v56
    v_lshlrev_b32 v55, 16, v63
    v_and_b32 v56, 0xffff0000, v63
    v_mul_f32 v57, s76, -abs(v55)
    v_mul_f32 v58, s76, -abs(v56)
    v_exp_f32 v57, v57
    v_exp_f32 v58, v58
    v_cmp_le_f32 vcc, 0, v55
    v_cmp_le_f32 s[78:79], 0, v56
    v_mul_f32 v59, v57, v57
    v_mul_f32 v60, v58, v58
    v_cndmask_b32 v61, v59, 1.0, vcc
    v_cndmask_b32 v62, v60, 1.0, s[78:79]
    v_cndmask_b32 v59, 1.0, v59, vcc
    v_cndmask_b32 v60, 1.0, v60, s[78:79]
    v_fma_f32 v61, v57, 2.0, v61
    v_fma_f32 v62, v58, 2.0, v62
    v_fma_f32 v59, v59, 2.0, v61
    v_fma_f32 v60, v60, 2.0, v62
    v_rcp_f32 v59, v59
    v_rcp_f32 v60, v60
    v_mul_f32 v61, v61, v55
    v_mul_f32 v62, v62, v56
    v_mul_f32 v57, v61, v59
    v_mul_f32 v58, v62, v60
    v_cvt_pk_bf16_f32 v145, v57, v58
    v_cvt_pk_bf16_f32 v63, v148, v149
    v_lshlrev_b32 v55, 16, v63
    v_and_b32 v56, 0xffff0000, v63
    v_add_f32 v55, v55, v23
    v_add_f32 v56, v56, v23
    v_cvt_pk_bf16_f32 v63, v55, v56
    v_lshlrev_b32 v55, 16, v63
    v_and_b32 v56, 0xffff0000, v63
    v_mul_f32 v57, s76, -abs(v55)
    v_mul_f32 v58, s76, -abs(v56)
    v_exp_f32 v57, v57
    v_exp_f32 v58, v58
    v_cmp_le_f32 vcc, 0, v55
    v_cmp_le_f32 s[78:79], 0, v56
    v_mul_f32 v59, v57, v57
    v_mul_f32 v60, v58, v58
    v_cndmask_b32 v61, v59, 1.0, vcc
    v_cndmask_b32 v62, v60, 1.0, s[78:79]
    v_cndmask_b32 v59, 1.0, v59, vcc
    v_cndmask_b32 v60, 1.0, v60, s[78:79]
    v_fma_f32 v61, v57, 2.0, v61
    v_fma_f32 v62, v58, 2.0, v62
    v_fma_f32 v59, v59, 2.0, v61
    v_fma_f32 v60, v60, 2.0, v62
    v_rcp_f32 v59, v59
    v_rcp_f32 v60, v60
    v_mul_f32 v61, v61, v55
    v_mul_f32 v62, v62, v56
    v_mul_f32 v57, v61, v59
    v_mul_f32 v58, v62, v60
    v_cvt_pk_bf16_f32 v146, v57, v58
    v_cvt_pk_bf16_f32 v63, v150, v151
    v_lshlrev_b32 v55, 16, v63
    v_and_b32 v56, 0xffff0000, v63
    v_add_f32 v55, v55, v23
    v_add_f32 v56, v56, v23
    v_cvt_pk_bf16_f32 v63, v55, v56
    v_lshlrev_b32 v55, 16, v63
    v_and_b32 v56, 0xffff0000, v63
    v_mul_f32 v57, s76, -abs(v55)
    v_mul_f32 v58, s76, -abs(v56)
    v_exp_f32 v57, v57
    v_exp_f32 v58, v58
    v_cmp_le_f32 vcc, 0, v55
    v_cmp_le_f32 s[78:79], 0, v56
    v_mul_f32 v59, v57, v57
    v_mul_f32 v60, v58, v58
    v_cndmask_b32 v61, v59, 1.0, vcc
    v_cndmask_b32 v62, v60, 1.0, s[78:79]
    v_cndmask_b32 v59, 1.0, v59, vcc
    v_cndmask_b32 v60, 1.0, v60, s[78:79]
    v_fma_f32 v61, v57, 2.0, v61
    v_fma_f32 v62, v58, 2.0, v62
    v_fma_f32 v59, v59, 2.0, v61
    v_fma_f32 v60, v60, 2.0, v62
    v_rcp_f32 v59, v59
    v_rcp_f32 v60, v60
    v_mul_f32 v61, v61, v55
    v_mul_f32 v62, v62, v56
    v_mul_f32 v57, v61, v59
    v_mul_f32 v58, v62, v60
    v_cvt_pk_bf16_f32 v147, v57, v58
    buffer_store_dwordx4 v[144:147], v45, s[52:55], s82 offen sc1
    v_mov_b32 v50, 157952
    v_mov_b32 v51, 1
    s_mov_b64 exec, 1
    ds_add_u32 v50, v51 offset:4
    s_mov_b64 exec, -1
    v_and_b32 v55, 1, v1
    v_mul_u32_u24 v55, 640, v55
    v_bfe_u32 v56, v1, 1, 3
    v_add_u32 v55, v55, v56
    s_mul_i32 s76, s65, 40
    v_add_u32 v55, s76, v55
    v_lshlrev_b32 v55, 7, v55
    v_add_u32 v45, v55, v46
    s_waitcnt vmcnt(0)
    s_lshl_b32 s77, s64, 4
    s_add_u32 s77, s77, s65
    s_lshl_b32 s83, s77, 7
    s_add_u32 s83, s83, 0xb40000
    s_lshl_b32 s77, s66, 2
    s_add_u32 s83, s83, s77
    v_mov_b32 v48, 1
    v_mov_b32 v49, 0
    s_mov_b64 exec, 1
    buffer_store_dword v48, v49, s[52:55], s83 offen sc1
    s_mov_b64 exec, -1
    v_mov_b32 v50, 157952
k1_yspin:
    ds_read_b32 v51, v50
    s_waitcnt lgkmcnt(0)
    v_readfirstlane_b32 s76, v51
    s_nop 3
    s_cmp_eq_u32 s76, 1
    s_cbranch_scc1 k1_ydone
    s_sleep 1
    s_branch k1_yspin
k1_ydone:
    ds_read_b32 v2, v44 offset:0
    ds_read_b32 v3, v44 offset:64
    ds_read_b32 v4, v44 offset:128
    ds_read_b32 v5, v44 offset:192
    ds_read_b32 v6, v44 offset:256
    s_waitcnt lgkmcnt(0)
    v_mul_f32 v7, v24, v2
    v_mul_f32 v8, v25, v3
    v_mul_f32 v9, v26, v4
    v_mul_f32 v10, v27, v5
    v_mul_f32 v11, v28, v6
    v_fmac_f32_dpp v7, v2, v29 quad_perm:[1,0,3,2] row_mask:0xf bank_mask:0xf
    v_fmac_f32_dpp v8, v3, v30 quad_perm:[1,0,3,2] row_mask:0xf bank_mask:0xf
    v_fmac_f32_dpp v9, v4, v31 quad_perm:[1,0,3,2] row_mask:0xf bank_mask:0xf
    v_fmac_f32_dpp v10, v5, v32 quad_perm:[1,0,3,2] row_mask:0xf bank_mask:0xf
    v_fmac_f32_dpp v11, v6, v33 quad_perm:[1,0,3,2] row_mask:0xf bank_mask:0xf
    v_add_f32 v64, v64, v7
    v_add_f32 v72, v72, v8
    v_add_f32 v80, v80, v9
    v_add_f32 v88, v88, v10
    v_add_f32 v96, v96, v11
    v_mul_f32 v2, v24, v7
    v_mul_f32 v3, v25, v8
    v_mul_f32 v4, v26, v9
    v_mul_f32 v5, v27, v10
    v_mul_f32 v6, v28, v11
    v_fmac_f32_dpp v2, v7, v29 quad_perm:[1,0,3,2] row_mask:0xf bank_mask:0xf
    v_fmac_f32_dpp v3, v8, v30 quad_perm:[1,0,3,2] row_mask:0xf bank_mask:0xf
    v_fmac_f32_dpp v4, v9, v31 quad_perm:[1,0,3,2] row_mask:0xf bank_mask:0xf
    v_fmac_f32_dpp v5, v10, v32 quad_perm:[1,0,3,2] row_mask:0xf bank_mask:0xf
    v_fmac_f32_dpp v6, v11, v33 quad_perm:[1,0,3,2] row_mask:0xf bank_mask:0xf
    v_add_f32 v65, v65, v2
    v_add_f32 v73, v73, v3
    v_add_f32 v81, v81, v4
    v_add_f32 v89, v89, v5
    v_add_f32 v97, v97, v6
    v_mul_f32 v7, v24, v2
    v_mul_f32 v8, v25, v3
    v_mul_f32 v9, v26, v4
    v_mul_f32 v10, v27, v5
    v_mul_f32 v11, v28, v6
    v_fmac_f32_dpp v7, v2, v29 quad_perm:[1,0,3,2] row_mask:0xf bank_mask:0xf
    v_fmac_f32_dpp v8, v3, v30 quad_perm:[1,0,3,2] row_mask:0xf bank_mask:0xf
    v_fmac_f32_dpp v9, v4, v31 quad_perm:[1,0,3,2] row_mask:0xf bank_mask:0xf
    v_fmac_f32_dpp v10, v5, v32 quad_perm:[1,0,3,2] row_mask:0xf bank_mask:0xf
    v_fmac_f32_dpp v11, v6, v33 quad_perm:[1,0,3,2] row_mask:0xf bank_mask:0xf
    v_add_f32 v66, v66, v7
    v_add_f32 v74, v74, v8
    v_add_f32 v82, v82, v9
    v_add_f32 v90, v90, v10
    v_add_f32 v98, v98, v11
    v_mul_f32 v2, v24, v7
    v_mul_f32 v3, v25, v8
    v_mul_f32 v4, v26, v9
    v_mul_f32 v5, v27, v10
    v_mul_f32 v6, v28, v11
    v_fmac_f32_dpp v2, v7, v29 quad_perm:[1,0,3,2] row_mask:0xf bank_mask:0xf
    v_fmac_f32_dpp v3, v8, v30 quad_perm:[1,0,3,2] row_mask:0xf bank_mask:0xf
    v_fmac_f32_dpp v4, v9, v31 quad_perm:[1,0,3,2] row_mask:0xf bank_mask:0xf
    v_fmac_f32_dpp v5, v10, v32 quad_perm:[1,0,3,2] row_mask:0xf bank_mask:0xf
    v_fmac_f32_dpp v6, v11, v33 quad_perm:[1,0,3,2] row_mask:0xf bank_mask:0xf
    v_add_f32 v67, v67, v2
    v_add_f32 v75, v75, v3
    v_add_f32 v83, v83, v4
    v_add_f32 v91, v91, v5
    v_add_f32 v99, v99, v6
    v_mul_f32 v7, v24, v2
    v_mul_f32 v8, v25, v3
    v_mul_f32 v9, v26, v4
    v_mul_f32 v10, v27, v5
    v_mul_f32 v11, v28, v6
    v_fmac_f32_dpp v7, v2, v29 quad_perm:[1,0,3,2] row_mask:0xf bank_mask:0xf
    v_fmac_f32_dpp v8, v3, v30 quad_perm:[1,0,3,2] row_mask:0xf bank_mask:0xf
    v_fmac_f32_dpp v9, v4, v31 quad_perm:[1,0,3,2] row_mask:0xf bank_mask:0xf
    v_fmac_f32_dpp v10, v5, v32 quad_perm:[1,0,3,2] row_mask:0xf bank_mask:0xf
    v_fmac_f32_dpp v11, v6, v33 quad_perm:[1,0,3,2] row_mask:0xf bank_mask:0xf
    v_add_f32 v68, v68, v7
    v_add_f32 v76, v76, v8
    v_add_f32 v84, v84, v9
    v_add_f32 v92, v92, v10
    v_add_f32 v100, v100, v11
    v_mul_f32 v2, v24, v7
    v_mul_f32 v3, v25, v8
    v_mul_f32 v4, v26, v9
    v_mul_f32 v5, v27, v10
    v_mul_f32 v6, v28, v11
    v_fmac_f32_dpp v2, v7, v29 quad_perm:[1,0,3,2] row_mask:0xf bank_mask:0xf
    v_fmac_f32_dpp v3, v8, v30 quad_perm:[1,0,3,2] row_mask:0xf bank_mask:0xf
    v_fmac_f32_dpp v4, v9, v31 quad_perm:[1,0,3,2] row_mask:0xf bank_mask:0xf
    v_fmac_f32_dpp v5, v10, v32 quad_perm:[1,0,3,2] row_mask:0xf bank_mask:0xf
    v_fmac_f32_dpp v6, v11, v33 quad_perm:[1,0,3,2] row_mask:0xf bank_mask:0xf
    v_add_f32 v69, v69, v2
    v_add_f32 v77, v77, v3
    v_add_f32 v85, v85, v4
    v_add_f32 v93, v93, v5
    v_add_f32 v101, v101, v6
    v_mul_f32 v7, v24, v2
    v_mul_f32 v8, v25, v3
    v_mul_f32 v9, v26, v4
    v_mul_f32 v10, v27, v5
    v_mul_f32 v11, v28, v6
    v_fmac_f32_dpp v7, v2, v29 quad_perm:[1,0,3,2] row_mask:0xf bank_mask:0xf
    v_fmac_f32_dpp v8, v3, v30 quad_perm:[1,0,3,2] row_mask:0xf bank_mask:0xf
    v_fmac_f32_dpp v9, v4, v31 quad_perm:[1,0,3,2] row_mask:0xf bank_mask:0xf
    v_fmac_f32_dpp v10, v5, v32 quad_perm:[1,0,3,2] row_mask:0xf bank_mask:0xf
    v_fmac_f32_dpp v11, v6, v33 quad_perm:[1,0,3,2] row_mask:0xf bank_mask:0xf
    v_add_f32 v70, v70, v7
    v_add_f32 v78, v78, v8
    v_add_f32 v86, v86, v9
    v_add_f32 v94, v94, v10
    v_add_f32 v102, v102, v11
    v_mul_f32 v2, v24, v7
    v_mul_f32 v3, v25, v8
    v_mul_f32 v4, v26, v9
    v_mul_f32 v5, v27, v10
    v_mul_f32 v6, v28, v11
    v_fmac_f32_dpp v2, v7, v29 quad_perm:[1,0,3,2] row_mask:0xf bank_mask:0xf
    v_fmac_f32_dpp v3, v8, v30 quad_perm:[1,0,3,2] row_mask:0xf bank_mask:0xf
    v_fmac_f32_dpp v4, v9, v31 quad_perm:[1,0,3,2] row_mask:0xf bank_mask:0xf
    v_fmac_f32_dpp v5, v10, v32 quad_perm:[1,0,3,2] row_mask:0xf bank_mask:0xf
    v_fmac_f32_dpp v6, v11, v33 quad_perm:[1,0,3,2] row_mask:0xf bank_mask:0xf
    v_add_f32 v71, v71, v2
    v_add_f32 v79, v79, v3
    v_add_f32 v87, v87, v4
    v_add_f32 v95, v95, v5
    v_add_f32 v103, v103, v6
    s_mov_b32 s76, 0
    v_mul_f32 v56, v34, v64
    v_mul_f32 v57, v34, v65
    v_mul_f32 v58, v34, v66
    v_mul_f32 v59, v34, v67
    v_mul_f32 v60, v34, v68
    v_mul_f32 v61, v34, v69
    v_mul_f32 v62, v34, v70
    v_mul_f32 v63, v34, v71
    v_fmac_f32_dpp v56, v64, v39 quad_perm:[1,0,3,2] row_mask:0xf bank_mask:0xf
    v_fmac_f32_dpp v57, v65, v39 quad_perm:[1,0,3,2] row_mask:0xf bank_mask:0xf
    v_fmac_f32_dpp v58, v66, v39 quad_perm:[1,0,3,2] row_mask:0xf bank_mask:0xf
    v_fmac_f32_dpp v59, v67, v39 quad_perm:[1,0,3,2] row_mask:0xf bank_mask:0xf
    v_fmac_f32_dpp v60, v68, v39 quad_perm:[1,0,3,2] row_mask:0xf bank_mask:0xf
    v_fmac_f32_dpp v61, v69, v39 quad_perm:[1,0,3,2] row_mask:0xf bank_mask:0xf
    v_fmac_f32_dpp v62, v70, v39 quad_perm:[1,0,3,2] row_mask:0xf bank_mask:0xf
    v_fmac_f32_dpp v63, v71, v39 quad_perm:[1,0,3,2] row_mask:0xf bank_mask:0xf
    v_cvt_pk_bf16_f32 v12, v56, v57
    v_cvt_pk_bf16_f32 v13, v58, v59
    v_cvt_pk_bf16_f32 v14, v60, v61
    v_cvt_pk_bf16_f32 v15, v62, v63
    buffer_store_dwordx4 v[12:15], v45, s[52:55], s76 offen sc1
    s_add_u32 s76, s76, 1024
    v_mul_f32 v56, v35, v72
    v_mul_f32 v57, v35, v73
    v_mul_f32 v58, v35, v74
    v_mul_f32 v59, v35, v75
    v_mul_f32 v60, v35, v76
    v_mul_f32 v61, v35, v77
    v_mul_f32 v62, v35, v78
    v_mul_f32 v63, v35, v79
    v_fmac_f32_dpp v56, v72, v40 quad_perm:[1,0,3,2] row_mask:0xf bank_mask:0xf
    v_fmac_f32_dpp v57, v73, v40 quad_perm:[1,0,3,2] row_mask:0xf bank_mask:0xf
    v_fmac_f32_dpp v58, v74, v40 quad_perm:[1,0,3,2] row_mask:0xf bank_mask:0xf
    v_fmac_f32_dpp v59, v75, v40 quad_perm:[1,0,3,2] row_mask:0xf bank_mask:0xf
    v_fmac_f32_dpp v60, v76, v40 quad_perm:[1,0,3,2] row_mask:0xf bank_mask:0xf
    v_fmac_f32_dpp v61, v77, v40 quad_perm:[1,0,3,2] row_mask:0xf bank_mask:0xf
    v_fmac_f32_dpp v62, v78, v40 quad_perm:[1,0,3,2] row_mask:0xf bank_mask:0xf
    v_fmac_f32_dpp v63, v79, v40 quad_perm:[1,0,3,2] row_mask:0xf bank_mask:0xf
    v_cvt_pk_bf16_f32 v2, v56, v57
    v_cvt_pk_bf16_f32 v3, v58, v59
    v_cvt_pk_bf16_f32 v4, v60, v61
    v_cvt_pk_bf16_f32 v5, v62, v63
    buffer_store_dwordx4 v[2:5], v45, s[52:55], s76 offen sc1
    s_add_u32 s76, s76, 1024
    v_mul_f32 v56, v36, v80
    v_mul_f32 v57, v36, v81
    v_mul_f32 v58, v36, v82
    v_mul_f32 v59, v36, v83
    v_mul_f32 v60, v36, v84
    v_mul_f32 v61, v36, v85
    v_mul_f32 v62, v36, v86
    v_mul_f32 v63, v36, v87
    v_fmac_f32_dpp v56, v80, v41 quad_perm:[1,0,3,2] row_mask:0xf bank_mask:0xf
    v_fmac_f32_dpp v57, v81, v41 quad_perm:[1,0,3,2] row_mask:0xf bank_mask:0xf
    v_fmac_f32_dpp v58, v82, v41 quad_perm:[1,0,3,2] row_mask:0xf bank_mask:0xf
    v_fmac_f32_dpp v59, v83, v41 quad_perm:[1,0,3,2] row_mask:0xf bank_mask:0xf
    v_fmac_f32_dpp v60, v84, v41 quad_perm:[1,0,3,2] row_mask:0xf bank_mask:0xf
    v_fmac_f32_dpp v61, v85, v41 quad_perm:[1,0,3,2] row_mask:0xf bank_mask:0xf
    v_fmac_f32_dpp v62, v86, v41 quad_perm:[1,0,3,2] row_mask:0xf bank_mask:0xf
    v_fmac_f32_dpp v63, v87, v41 quad_perm:[1,0,3,2] row_mask:0xf bank_mask:0xf
    v_cvt_pk_bf16_f32 v12, v56, v57
    v_cvt_pk_bf16_f32 v13, v58, v59
    v_cvt_pk_bf16_f32 v14, v60, v61
    v_cvt_pk_bf16_f32 v15, v62, v63
    buffer_store_dwordx4 v[12:15], v45, s[52:55], s76 offen sc1
    s_add_u32 s76, s76, 1024
    v_mul_f32 v56, v37, v88
    v_mul_f32 v57, v37, v89
    v_mul_f32 v58, v37, v90
    v_mul_f32 v59, v37, v91
    v_mul_f32 v60, v37, v92
    v_mul_f32 v61, v37, v93
    v_mul_f32 v62, v37, v94
    v_mul_f32 v63, v37, v95
    v_fmac_f32_dpp v56, v88, v42 quad_perm:[1,0,3,2] row_mask:0xf bank_mask:0xf
    v_fmac_f32_dpp v57, v89, v42 quad_perm:[1,0,3,2] row_mask:0xf bank_mask:0xf
    v_fmac_f32_dpp v58, v90, v42 quad_perm:[1,0,3,2] row_mask:0xf bank_mask:0xf
    v_fmac_f32_dpp v59, v91, v42 quad_perm:[1,0,3,2] row_mask:0xf bank_mask:0xf
    v_fmac_f32_dpp v60, v92, v42 quad_perm:[1,0,3,2] row_mask:0xf bank_mask:0xf
    v_fmac_f32_dpp v61, v93, v42 quad_perm:[1,0,3,2] row_mask:0xf bank_mask:0xf
    v_fmac_f32_dpp v62, v94, v42 quad_perm:[1,0,3,2] row_mask:0xf bank_mask:0xf
    v_fmac_f32_dpp v63, v95, v42 quad_perm:[1,0,3,2] row_mask:0xf bank_mask:0xf
    v_cvt_pk_bf16_f32 v2, v56, v57
    v_cvt_pk_bf16_f32 v3, v58, v59
    v_cvt_pk_bf16_f32 v4, v60, v61
    v_cvt_pk_bf16_f32 v5, v62, v63
    buffer_store_dwordx4 v[2:5], v45, s[52:55], s76 offen sc1
    s_add_u32 s76, s76, 1024
    v_mul_f32 v56, v38, v96
    v_mul_f32 v57, v38, v97
    v_mul_f32 v58, v38, v98
    v_mul_f32 v59, v38, v99
    v_mul_f32 v60, v38, v100
    v_mul_f32 v61, v38, v101
    v_mul_f32 v62, v38, v102
    v_mul_f32 v63, v38, v103
    v_fmac_f32_dpp v56, v96, v43 quad_perm:[1,0,3,2] row_mask:0xf bank_mask:0xf
    v_fmac_f32_dpp v57, v97, v43 quad_perm:[1,0,3,2] row_mask:0xf bank_mask:0xf
    v_fmac_f32_dpp v58, v98, v43 quad_perm:[1,0,3,2] row_mask:0xf bank_mask:0xf
    v_fmac_f32_dpp v59, v99, v43 quad_perm:[1,0,3,2] row_mask:0xf bank_mask:0xf
    v_fmac_f32_dpp v60, v100, v43 quad_perm:[1,0,3,2] row_mask:0xf bank_mask:0xf
    v_fmac_f32_dpp v61, v101, v43 quad_perm:[1,0,3,2] row_mask:0xf bank_mask:0xf
    v_fmac_f32_dpp v62, v102, v43 quad_perm:[1,0,3,2] row_mask:0xf bank_mask:0xf
    v_fmac_f32_dpp v63, v103, v43 quad_perm:[1,0,3,2] row_mask:0xf bank_mask:0xf
    v_cvt_pk_bf16_f32 v12, v56, v57
    v_cvt_pk_bf16_f32 v13, v58, v59
    v_cvt_pk_bf16_f32 v14, v60, v61
    v_cvt_pk_bf16_f32 v15, v62, v63
    buffer_store_dwordx4 v[12:15], v45, s[52:55], s76 offen sc1
    s_nop 1
    v_and_b32 v24, 15, v1
    v_lshrrev_b32 v25, 4, v1
    v_lshrrev_b32 v26, 2, v24
    v_lshl_add_u32 v27, v25, 3, v26
    v_lshlrev_b32 v27, 7, v27
    v_bfe_u32 v28, v26, 1, 1
    v_and_b32 v29, 1, v25
    v_lshl_add_u32 v28, v29, 1, v28
    v_xor_b32 v28, s66, v28
    v_lshl_add_u32 v27, v28, 5, v27
    v_and_b32 v28, 3, v24
    v_lshl_add_u32 v16, v28, 3, v27
    v_lshlrev_b32 v27, 8, v24
    v_add_u32 v27, 16384, v27
    v_add_u32 v28, 0, v25
    v_xor_b32 v28, v28, v24
    v_lshl_add_u32 v17, v28, 4, v27
    v_add_u32 v28, 4, v25
    v_xor_b32 v28, v28, v24
    v_lshl_add_u32 v18, v28, 4, v27
    v_add_u32 v28, 8, v25
    v_xor_b32 v28, v28, v24
    v_lshl_add_u32 v19, v28, 4, v27
    v_add_u32 v28, 12, v25
    v_xor_b32 v28, v28, v24
    v_lshl_add_u32 v20, v28, 4, v27
    s_mov_b32 s74, 0
    v_mov_b32 v48, 0
    v_mov_b32 v49, 0
    v_mov_b32 v50, 0
    v_mov_b32 v51, 0
    v_mov_b32 v52, 0
    v_mov_b32 v53, 0
    v_mov_b32 v54, 0
    v_mov_b32 v55, 0
    v_mov_b32 v56, 0
    v_mov_b32 v57, 0
    v_mov_b32 v58, 0
    v_mov_b32 v59, 0
    v_mov_b32 v60, 0
    v_mov_b32 v61, 0
    v_mov_b32 v62, 0
    v_mov_b32 v63, 0
    v_mov_b32 v64, 0
    v_mov_b32 v65, 0
    v_mov_b32 v66, 0
    v_mov_b32 v67, 0
    s_mov_b32 s40, s10
    s_and_b32 s41, s11, 0xffff
    s_mov_b32 s42, 5242880
    s_mov_b32 s43, 0x00020000
    s_lshl_b32 s76, s12, 6
    s_lshl_b32 s77, s66, 4
    s_add_u32 s76, s76, s77
    v_and_b32 v24, 15, v1
    v_add_u32 v24, s76, v24
    v_mov_b32 v32, v24
    s_mul_i32 s77, s13, 80
    v_lshrrev_b32 v25, 4, v1
    v_lshlrev_b32 v25, 2, v25
    v_add_u32 v33, s77, v25
    v_mul_u32_u24 v26, 1280, v24
    v_lshl_add_u32 v26, v33, 1, v26
    v_lshlrev_b32 v27, 1, v33
    global_load_dwordx2 v[88:89], v26, s[16:17] offset:0
    global_load_dwordx2 v[98:99], v27, s[8:9] offset:0
    global_load_dwordx2 v[90:91], v26, s[16:17] offset:32
    global_load_dwordx2 v[100:101], v27, s[8:9] offset:32
    global_load_dwordx2 v[92:93], v26, s[16:17] offset:64
    global_load_dwordx2 v[102:103], v27, s[8:9] offset:64
    global_load_dwordx2 v[94:95], v26, s[16:17] offset:96
    global_load_dwordx2 v[104:105], v27, s[8:9] offset:96
    global_load_dwordx2 v[96:97], v26, s[16:17] offset:128
    global_load_dwordx2 v[106:107], v27, s[8:9] offset:128
    s_barrier
    ds_read_b64_tr_b16 a[0:1], v16 offset:0
    ds_read_b64_tr_b16 a[2:3], v16 offset:512
    ds_read_b128 a[4:7], v17 offset:0
    ds_read_b128 a[8:11], v17 offset:4096
    ds_read_b128 a[12:15], v17 offset:8192
    ds_read_b128 a[16:19], v17 offset:12288
    ds_read_b128 a[20:23], v17 offset:16384
    ds_read_b64_tr_b16 a[24:25], v16 offset:4096
    ds_read_b64_tr_b16 a[26:27], v16 offset:4608
    ds_read_b128 a[28:31], v18 offset:0
    ds_read_b128 a[32:35], v18 offset:4096
    ds_read_b128 a[36:39], v18 offset:8192
    ds_read_b128 a[40:43], v18 offset:12288
    ds_read_b128 a[44:47], v18 offset:16384
    s_mov_b32 s72, 0
k2_loop:
    s_waitcnt lgkmcnt(0)
    v_mfma_f32_16x16x32_bf16 v[48:51], a[4:7], a[0:3], v[48:51]
    ds_read_b64_tr_b16 a[48:49], v16 offset:8192
    ds_read_b64_tr_b16 a[50:51], v16 offset:8704
    v_mfma_f32_16x16x32_bf16 v[52:55], a[8:11], a[0:3], v[52:55]
    ds_read_b128 a[52:55], v19 offset:0
    v_mfma_f32_16x16x32_bf16 v[56:59], a[12:15], a[0:3], v[56:59]
    ds_read_b128 a[56:59], v19 offset:4096
    ds_read_b128 a[60:63], v19 offset:8192
    v_mfma_f32_16x16x32_bf16 v[60:63], a[16:19], a[0:3], v[60:63]
    ds_read_b128 a[64:67], v19 offset:12288
    v_mfma_f32_16x16x32_bf16 v[64:67], a[20:23], a[0:3], v[64:67]
    ds_read_b128 a[68:71], v19 offset:16384
    v_mfma_f32_16x16x32_bf16 v[48:51], a[28:31], a[24:27], v[48:51]
    ds_read_b64_tr_b16 a[72:73], v16 offset:12288
    ds_read_b64_tr_b16 a[74:75], v16 offset:12800
    v_mfma_f32_16x16x32_bf16 v[52:55], a[32:35], a[24:27], v[52:55]
    ds_read_b128 a[76:79], v20 offset:0
    v_mfma_f32_16x16x32_bf16 v[56:59], a[36:39], a[24:27], v[56:59]
    ds_read_b128 a[80:83], v20 offset:4096
    ds_read_b128 a[84:87], v20 offset:8192
    v_mfma_f32_16x16x32_bf16 v[60:63], a[40:43], a[24:27], v[60:63]
    ds_read_b128 a[88:91], v20 offset:12288
    v_mfma_f32_16x16x32_bf16 v[64:67], a[44:47], a[24:27], v[64:67]
    ds_read_b128 a[92:95], v20 offset:16384
    s_waitcnt lgkmcnt(0)
    s_barrier
    v_mfma_f32_16x16x32_bf16 v[48:51], a[52:55], a[48:51], v[48:51]
    s_add_u32 s77, s74, 36864
    s_cmp_ge_u32 s77, 147456
    s_cselect_b32 s77, 0, s77
    s_sub_u32 s78, s77, s74
    s_mov_b32 s74, s77
    v_add_u32 v16, s78, v16
    v_mfma_f32_16x16x32_bf16 v[52:55], a[56:59], a[48:51], v[52:55]
    v_add_u32 v17, s78, v17
    v_add_u32 v18, s78, v18
    v_mfma_f32_16x16x32_bf16 v[56:59], a[60:63], a[48:51], v[56:59]
    v_add_u32 v19, s78, v19
    v_add_u32 v20, s78, v20
    v_mfma_f32_16x16x32_bf16 v[60:63], a[64:67], a[48:51], v[60:63]
    ds_read_b64_tr_b16 a[0:1], v16 offset:0
    ds_read_b64_tr_b16 a[2:3], v16 offset:512
    v_mfma_f32_16x16x32_bf16 v[64:67], a[68:71], a[48:51], v[64:67]
    ds_read_b128 a[4:7], v17 offset:0
    ds_read_b128 a[8:11], v17 offset:4096
    v_mfma_f32_16x16x32_bf16 v[48:51], a[76:79], a[72:75], v[48:51]
    ds_read_b128 a[12:15], v17 offset:8192
    ds_read_b128 a[16:19], v17 offset:12288
    v_mfma_f32_16x16x32_bf16 v[52:55], a[80:83], a[72:75], v[52:55]
    ds_read_b128 a[20:23], v17 offset:16384
    ds_read_b64_tr_b16 a[24:25], v16 offset:4096
    v_mfma_f32_16x16x32_bf16 v[56:59], a[84:87], a[72:75], v[56:59]
    ds_read_b64_tr_b16 a[26:27], v16 offset:4608
    ds_read_b128 a[28:31], v18 offset:0
    v_mfma_f32_16x16x32_bf16 v[60:63], a[88:91], a[72:75], v[60:63]
    ds_read_b128 a[32:35], v18 offset:4096
    ds_read_b128 a[36:39], v18 offset:8192
    v_mfma_f32_16x16x32_bf16 v[64:67], a[92:95], a[72:75], v[64:67]
    ds_read_b128 a[40:43], v18 offset:12288
    ds_read_b128 a[44:47], v18 offset:16384
    s_add_u32 s72, s72, 1
    s_cmp_eq_u32 s72, 2
    s_cbranch_scc0 k2_nohtag
    s_waitcnt vmcnt(0)
    v_mov_b32 v30, 1
    v_mov_b32 v31, 0
    s_mov_b64 exec, 1
    buffer_store_dword v30, v31, s[52:55], s83 offen offset:16 sc1
    s_mov_b64 exec, -1
k2_nohtag:
    s_cmp_eq_u32 s72, 12
    s_cbranch_scc0 k2_nosw
    s_nop 9
    v_mov_b32 v68, v48
    v_mov_b32 v69, v49
    v_mov_b32 v70, v50
    v_mov_b32 v71, v51
    v_mov_b32 v72, v52
    v_mov_b32 v73, v53
    v_mov_b32 v74, v54
    v_mov_b32 v75, v55
    v_mov_b32 v76, v56
    v_mov_b32 v77, v57
    v_mov_b32 v78, v58
    v_mov_b32 v79, v59
    v_mov_b32 v80, v60
    v_mov_b32 v81, v61
    v_mov_b32 v82, v62
    v_mov_b32 v83, v63
    v_mov_b32 v84, v64
    v_mov_b32 v85, v65
    v_mov_b32 v86, v66
    v_mov_b32 v87, v67
    v_mov_b32 v48, 0
    v_mov_b32 v49, 0
    v_mov_b32 v50, 0
    v_mov_b32 v51, 0
    v_mov_b32 v52, 0
    v_mov_b32 v53, 0
    v_mov_b32 v54, 0
    v_mov_b32 v55, 0
    v_mov_b32 v56, 0
    v_mov_b32 v57, 0
    v_mov_b32 v58, 0
    v_mov_b32 v59, 0
    v_mov_b32 v60, 0
    v_mov_b32 v61, 0
    v_mov_b32 v62, 0
    v_mov_b32 v63, 0
    v_mov_b32 v64, 0
    v_mov_b32 v65, 0
    v_mov_b32 v66, 0
    v_mov_b32 v67, 0
    s_nop 1
k2_nosw:
    s_cmp_eq_u32 s72, 16
    s_cbranch_scc0 k2_nog
    v_lshlrev_b32 v28, 2, v32
    v_add_u32 v28, 0xb00000, v28
    buffer_load_dword v108, v28, s[52:55], 0 offen sc1
k2_nog:
    s_cmp_lt_u32 s72, 21
    s_cbranch_scc1 k2_loop
    s_waitcnt lgkmcnt(0)
    v_mfma_f32_16x16x32_bf16 v[48:51], a[4:7], a[0:3], v[48:51]
    ds_read_b64_tr_b16 a[48:49], v16 offset:8192
    ds_read_b64_tr_b16 a[50:51], v16 offset:8704
    v_mfma_f32_16x16x32_bf16 v[52:55], a[8:11], a[0:3], v[52:55]
    ds_read_b128 a[52:55], v19 offset:0
    v_mfma_f32_16x16x32_bf16 v[56:59], a[12:15], a[0:3], v[56:59]
    ds_read_b128 a[56:59], v19 offset:4096
    ds_read_b128 a[60:63], v19 offset:8192
    v_mfma_f32_16x16x32_bf16 v[60:63], a[16:19], a[0:3], v[60:63]
    ds_read_b128 a[64:67], v19 offset:12288
    v_mfma_f32_16x16x32_bf16 v[64:67], a[20:23], a[0:3], v[64:67]
    ds_read_b128 a[68:71], v19 offset:16384
    v_mfma_f32_16x16x32_bf16 v[48:51], a[28:31], a[24:27], v[48:51]
    ds_read_b64_tr_b16 a[72:73], v16 offset:12288
    ds_read_b64_tr_b16 a[74:75], v16 offset:12800
    v_mfma_f32_16x16x32_bf16 v[52:55], a[32:35], a[24:27], v[52:55]
    ds_read_b128 a[76:79], v20 offset:0
    v_mfma_f32_16x16x32_bf16 v[56:59], a[36:39], a[24:27], v[56:59]
    ds_read_b128 a[80:83], v20 offset:4096
    ds_read_b128 a[84:87], v20 offset:8192
    v_mfma_f32_16x16x32_bf16 v[60:63], a[40:43], a[24:27], v[60:63]
    ds_read_b128 a[88:91], v20 offset:12288
    v_mfma_f32_16x16x32_bf16 v[64:67], a[44:47], a[24:27], v[64:67]
    ds_read_b128 a[92:95], v20 offset:16384
    s_waitcnt lgkmcnt(0)
    v_mfma_f32_16x16x32_bf16 v[48:51], a[52:55], a[48:51], v[48:51]
    v_mfma_f32_16x16x32_bf16 v[52:55], a[56:59], a[48:51], v[52:55]
    v_mfma_f32_16x16x32_bf16 v[56:59], a[60:63], a[48:51], v[56:59]
    v_mfma_f32_16x16x32_bf16 v[60:63], a[64:67], a[48:51], v[60:63]
    v_mfma_f32_16x16x32_bf16 v[64:67], a[68:71], a[48:51], v[64:67]
    v_mfma_f32_16x16x32_bf16 v[48:51], a[76:79], a[72:75], v[48:51]
    v_mfma_f32_16x16x32_bf16 v[52:55], a[80:83], a[72:75], v[52:55]
    v_mfma_f32_16x16x32_bf16 v[56:59], a[84:87], a[72:75], v[56:59]
    v_mfma_f32_16x16x32_bf16 v[60:63], a[88:91], a[72:75], v[60:63]
    v_mfma_f32_16x16x32_bf16 v[64:67], a[92:95], a[72:75], v[64:67]
    s_nop 9
    s_waitcnt vmcnt(0)
    v_sub_f32 v34, 1.0, v108
    v_cvt_pk_bf16_f32 v34, v34, v34
    v_lshlrev_b32 v34, 16, v34
    v_mul_u32_u24 v24, 2560, v32
    v_lshl_add_u32 v24, v33, 2, v24
    v_lshlrev_b32 v36, 16, v88
    v_and_b32 v37, 0xffff0000, v88
    v_lshlrev_b32 v38, 16, v98
    v_and_b32 v39, 0xffff0000, v98
    v_mul_f32 v36, v36, v38
    v_mul_f32 v37, v37, v39
    v_cvt_pk_bf16_f32 v36, v36, v37
    v_lshlrev_b32 v37, 16, v36
    v_and_b32 v36, 0xffff0000, v36
    v_add_f32 v48, v48, v37
    v_add_f32 v49, v49, v36
    v_cvt_pk_bf16_f32 v38, v68, v69
    v_lshlrev_b32 v39, 16, v38
    v_and_b32 v38, 0xffff0000, v38
    v_mul_f32 v39, v34, v39
    v_mul_f32 v38, v34, v38
    v_cvt_pk_bf16_f32 v38, v39, v38
    v_lshlrev_b32 v39, 16, v38
    v_and_b32 v38, 0xffff0000, v38
    v_mul_f32 v48, v108, v48
    v_mul_f32 v49, v108, v49
    v_add_f32 v48, v48, v39
    v_add_f32 v49, v49, v38
    v_lshlrev_b32 v36, 16, v89
    v_and_b32 v37, 0xffff0000, v89
    v_lshlrev_b32 v38, 16, v99
    v_and_b32 v39, 0xffff0000, v99
    v_mul_f32 v36, v36, v38
    v_mul_f32 v37, v37, v39
    v_cvt_pk_bf16_f32 v36, v36, v37
    v_lshlrev_b32 v37, 16, v36
    v_and_b32 v36, 0xffff0000, v36
    v_add_f32 v50, v50, v37
    v_add_f32 v51, v51, v36
    v_cvt_pk_bf16_f32 v38, v70, v71
    v_lshlrev_b32 v39, 16, v38
    v_and_b32 v38, 0xffff0000, v38
    v_mul_f32 v39, v34, v39
    v_mul_f32 v38, v34, v38
    v_cvt_pk_bf16_f32 v38, v39, v38
    v_lshlrev_b32 v39, 16, v38
    v_and_b32 v38, 0xffff0000, v38
    v_mul_f32 v50, v108, v50
    v_mul_f32 v51, v108, v51
    v_add_f32 v50, v50, v39
    v_add_f32 v51, v51, v38
    buffer_store_dwordx4 v[48:51], v24, s[40:43], 0 offen offset:0
    v_lshlrev_b32 v36, 16, v90
    v_and_b32 v37, 0xffff0000, v90
    v_lshlrev_b32 v38, 16, v100
    v_and_b32 v39, 0xffff0000, v100
    v_mul_f32 v36, v36, v38
    v_mul_f32 v37, v37, v39
    v_cvt_pk_bf16_f32 v36, v36, v37
    v_lshlrev_b32 v37, 16, v36
    v_and_b32 v36, 0xffff0000, v36
    v_add_f32 v52, v52, v37
    v_add_f32 v53, v53, v36
    v_cvt_pk_bf16_f32 v38, v72, v73
    v_lshlrev_b32 v39, 16, v38
    v_and_b32 v38, 0xffff0000, v38
    v_mul_f32 v39, v34, v39
    v_mul_f32 v38, v34, v38
    v_cvt_pk_bf16_f32 v38, v39, v38
    v_lshlrev_b32 v39, 16, v38
    v_and_b32 v38, 0xffff0000, v38
    v_mul_f32 v52, v108, v52
    v_mul_f32 v53, v108, v53
    v_add_f32 v52, v52, v39
    v_add_f32 v53, v53, v38
    v_lshlrev_b32 v36, 16, v91
    v_and_b32 v37, 0xffff0000, v91
    v_lshlrev_b32 v38, 16, v101
    v_and_b32 v39, 0xffff0000, v101
    v_mul_f32 v36, v36, v38
    v_mul_f32 v37, v37, v39
    v_cvt_pk_bf16_f32 v36, v36, v37
    v_lshlrev_b32 v37, 16, v36
    v_and_b32 v36, 0xffff0000, v36
    v_add_f32 v54, v54, v37
    v_add_f32 v55, v55, v36
    v_cvt_pk_bf16_f32 v38, v74, v75
    v_lshlrev_b32 v39, 16, v38
    v_and_b32 v38, 0xffff0000, v38
    v_mul_f32 v39, v34, v39
    v_mul_f32 v38, v34, v38
    v_cvt_pk_bf16_f32 v38, v39, v38
    v_lshlrev_b32 v39, 16, v38
    v_and_b32 v38, 0xffff0000, v38
    v_mul_f32 v54, v108, v54
    v_mul_f32 v55, v108, v55
    v_add_f32 v54, v54, v39
    v_add_f32 v55, v55, v38
    buffer_store_dwordx4 v[52:55], v24, s[40:43], 0 offen offset:64
    v_lshlrev_b32 v36, 16, v92
    v_and_b32 v37, 0xffff0000, v92
    v_lshlrev_b32 v38, 16, v102
    v_and_b32 v39, 0xffff0000, v102
    v_mul_f32 v36, v36, v38
    v_mul_f32 v37, v37, v39
    v_cvt_pk_bf16_f32 v36, v36, v37
    v_lshlrev_b32 v37, 16, v36
    v_and_b32 v36, 0xffff0000, v36
    v_add_f32 v56, v56, v37
    v_add_f32 v57, v57, v36
    v_cvt_pk_bf16_f32 v38, v76, v77
    v_lshlrev_b32 v39, 16, v38
    v_and_b32 v38, 0xffff0000, v38
    v_mul_f32 v39, v34, v39
    v_mul_f32 v38, v34, v38
    v_cvt_pk_bf16_f32 v38, v39, v38
    v_lshlrev_b32 v39, 16, v38
    v_and_b32 v38, 0xffff0000, v38
    v_mul_f32 v56, v108, v56
    v_mul_f32 v57, v108, v57
    v_add_f32 v56, v56, v39
    v_add_f32 v57, v57, v38
    v_lshlrev_b32 v36, 16, v93
    v_and_b32 v37, 0xffff0000, v93
    v_lshlrev_b32 v38, 16, v103
    v_and_b32 v39, 0xffff0000, v103
    v_mul_f32 v36, v36, v38
    v_mul_f32 v37, v37, v39
    v_cvt_pk_bf16_f32 v36, v36, v37
    v_lshlrev_b32 v37, 16, v36
    v_and_b32 v36, 0xffff0000, v36
    v_add_f32 v58, v58, v37
    v_add_f32 v59, v59, v36
    v_cvt_pk_bf16_f32 v38, v78, v79
    v_lshlrev_b32 v39, 16, v38
    v_and_b32 v38, 0xffff0000, v38
    v_mul_f32 v39, v34, v39
    v_mul_f32 v38, v34, v38
    v_cvt_pk_bf16_f32 v38, v39, v38
    v_lshlrev_b32 v39, 16, v38
    v_and_b32 v38, 0xffff0000, v38
    v_mul_f32 v58, v108, v58
    v_mul_f32 v59, v108, v59
    v_add_f32 v58, v58, v39
    v_add_f32 v59, v59, v38
    buffer_store_dwordx4 v[56:59], v24, s[40:43], 0 offen offset:128
    v_lshlrev_b32 v36, 16, v94
    v_and_b32 v37, 0xffff0000, v94
    v_lshlrev_b32 v38, 16, v104
    v_and_b32 v39, 0xffff0000, v104
    v_mul_f32 v36, v36, v38
    v_mul_f32 v37, v37, v39
    v_cvt_pk_bf16_f32 v36, v36, v37
    v_lshlrev_b32 v37, 16, v36
    v_and_b32 v36, 0xffff0000, v36
    v_add_f32 v60, v60, v37
    v_add_f32 v61, v61, v36
    v_cvt_pk_bf16_f32 v38, v80, v81
    v_lshlrev_b32 v39, 16, v38
    v_and_b32 v38, 0xffff0000, v38
    v_mul_f32 v39, v34, v39
    v_mul_f32 v38, v34, v38
    v_cvt_pk_bf16_f32 v38, v39, v38
    v_lshlrev_b32 v39, 16, v38
    v_and_b32 v38, 0xffff0000, v38
    v_mul_f32 v60, v108, v60
    v_mul_f32 v61, v108, v61
    v_add_f32 v60, v60, v39
    v_add_f32 v61, v61, v38
    v_lshlrev_b32 v36, 16, v95
    v_and_b32 v37, 0xffff0000, v95
    v_lshlrev_b32 v38, 16, v105
    v_and_b32 v39, 0xffff0000, v105
    v_mul_f32 v36, v36, v38
    v_mul_f32 v37, v37, v39
    v_cvt_pk_bf16_f32 v36, v36, v37
    v_lshlrev_b32 v37, 16, v36
    v_and_b32 v36, 0xffff0000, v36
    v_add_f32 v62, v62, v37
    v_add_f32 v63, v63, v36
    v_cvt_pk_bf16_f32 v38, v82, v83
    v_lshlrev_b32 v39, 16, v38
    v_and_b32 v38, 0xffff0000, v38
    v_mul_f32 v39, v34, v39
    v_mul_f32 v38, v34, v38
    v_cvt_pk_bf16_f32 v38, v39, v38
    v_lshlrev_b32 v39, 16, v38
    v_and_b32 v38, 0xffff0000, v38
    v_mul_f32 v62, v108, v62
    v_mul_f32 v63, v108, v63
    v_add_f32 v62, v62, v39
    v_add_f32 v63, v63, v38
    buffer_store_dwordx4 v[60:63], v24, s[40:43], 0 offen offset:192
    v_lshlrev_b32 v36, 16, v96
    v_and_b32 v37, 0xffff0000, v96
    v_lshlrev_b32 v38, 16, v106
    v_and_b32 v39, 0xffff0000, v106
    v_mul_f32 v36, v36, v38
    v_mul_f32 v37, v37, v39
    v_cvt_pk_bf16_f32 v36, v36, v37
    v_lshlrev_b32 v37, 16, v36
    v_and_b32 v36, 0xffff0000, v36
    v_add_f32 v64, v64, v37
    v_add_f32 v65, v65, v36
    v_cvt_pk_bf16_f32 v38, v84, v85
    v_lshlrev_b32 v39, 16, v38
    v_and_b32 v38, 0xffff0000, v38
    v_mul_f32 v39, v34, v39
    v_mul_f32 v38, v34, v38
    v_cvt_pk_bf16_f32 v38, v39, v38
    v_lshlrev_b32 v39, 16, v38
    v_and_b32 v38, 0xffff0000, v38
    v_mul_f32 v64, v108, v64
    v_mul_f32 v65, v108, v65
    v_add_f32 v64, v64, v39
    v_add_f32 v65, v65, v38
    v_lshlrev_b32 v36, 16, v97
    v_and_b32 v37, 0xffff0000, v97
    v_lshlrev_b32 v38, 16, v107
    v_and_b32 v39, 0xffff0000, v107
    v_mul_f32 v36, v36, v38
    v_mul_f32 v37, v37, v39
    v_cvt_pk_bf16_f32 v36, v36, v37
    v_lshlrev_b32 v37, 16, v36
    v_and_b32 v36, 0xffff0000, v36
    v_add_f32 v66, v66, v37
    v_add_f32 v67, v67, v36
    v_cvt_pk_bf16_f32 v38, v86, v87
    v_lshlrev_b32 v39, 16, v38
    v_and_b32 v38, 0xffff0000, v38
    v_mul_f32 v39, v34, v39
    v_mul_f32 v38, v34, v38
    v_cvt_pk_bf16_f32 v38, v39, v38
    v_lshlrev_b32 v39, 16, v38
    v_and_b32 v38, 0xffff0000, v38
    v_mul_f32 v66, v108, v66
    v_mul_f32 v67, v108, v67
    v_add_f32 v66, v66, v39
    v_add_f32 v67, v67, v38
    buffer_store_dwordx4 v[64:67], v24, s[40:43], 0 offen offset:256
k_end:
    s_endpgm
.section .rodata,"a"
.p2align 6
.amdhsa_kernel gated_mix__ssm_conv_s5__dense_activation_mish__prompt_kernel
  .amdhsa_next_free_vgpr 256
  .amdhsa_next_free_sgpr 102
  .amdhsa_accum_offset 152
  .amdhsa_group_segment_fixed_size 0
  .amdhsa_kernarg_size 136
  .amdhsa_user_sgpr_count 2
  .amdhsa_user_sgpr_kernarg_segment_ptr 1
  .amdhsa_system_sgpr_workgroup_id_x 1
.end_amdhsa_kernel
```
